```python
import torch

def _softmax(x, axis=-1):
    return torch.softmax(x, dim=axis)
def _gelu(x):
    return torch.nn.functional.gelu(x, approximate="tanh")
def _silu(x):
    return torch.nn.functional.silu(x)
def _sigmoid(x):
    return torch.sigmoid(x)
def _layernorm(x, axis=-1, eps=1e-5):
    m = x.mean(dim=axis, keepdim=True)
    v = x.var(dim=axis, keepdim=True, unbiased=False)
    return (x - m) / torch.sqrt(v + eps)
def _scatter_add(tgt, idx, src, axis=0):
    return tgt.clone().index_add_(axis, idx, src)
def _segment_sum(src, seg, n):
    out = torch.zeros((n,) + src.shape[1:], dtype=src.dtype)
    return out.index_add_(0, seg, src)
def _pad(x, pw):
    flat = tuple(v for pair in reversed(pw) for v in pair)
    return torch.nn.functional.pad(x, flat)

kernel_name = 'standalone__modern_conv_block_slak__vision'

def setup_inputs():

    _w = (lambda a: (lambda t: t.to(torch.bfloat16) if t.is_floating_point() else t)(torch.as_tensor(a)))
    H = W = 224
    C = 96
    K = 5
    return {
        "x": _w((lambda *s: torch.randn(*s, dtype=torch.bfloat16) * 0.05)(1, H, W, C)),
        "dw": _w((lambda *s: torch.randn(*s, dtype=torch.bfloat16) * 0.05)(K, K, C)),
        "w1": _w((lambda *s: torch.randn(*s, dtype=torch.bfloat16) * 0.05)(C, 4 * C)),
        "w2": _w((lambda *s: torch.randn(*s, dtype=torch.bfloat16) * 0.05)(4 * C, C)),
        "grn_g": _w((lambda *s: torch.randn(*s, dtype=torch.bfloat16) * 0.05)(4 * C)),
        "grn_b": _w((lambda *s: torch.randn(*s, dtype=torch.bfloat16) * 0.05)(4 * C)),
    }

def reference(x, dw, w1, w2, grn_g, grn_b):
    B, H, W, C = x.shape
    K = dw.shape[0]
    pad = K // 2
    xp = _pad(x, ((0,0),(pad,pad),(pad,pad),(0,0)))
    out = torch.zeros_like(x)
    for i in range(K):
        for j in range(K):
            out = out + xp[:, i:i+H, j:j+W, :] * dw[i, j][None, None, None, :]
    h = _layernorm(out, axis=-1)
    h = _gelu(h @ w1)
    gx = torch.sqrt((h * h).sum(axis=(1, 2), keepdims=True) + 1e-6)
    nx = gx / (gx.mean(axis=-1, keepdims=True) + 1e-6)
    h = grn_g[None, None, None, :] * (h * nx) + grn_b[None, None, None, :] + h
    return x + h @ w2
```

```asm
; @launch grid=(256,1,1) block=(256,1,1) lds=163840
.amdgcn_target "amdgcn-amd-amdhsa--gfx950"
.text
.globl standalone__modern_conv_block_slak__vision_kernel
.p2align 8
.type standalone__modern_conv_block_slak__vision_kernel,@function
standalone__modern_conv_block_slak__vision_kernel:
  s_cmp_ge_u32 s2, 256
  s_cbranch_scc1 L_end
  s_load_dwordx16 s[4:19], s[0:1], 0
  s_load_dwordx2 s[20:21], s[0:1], 64
  s_getpc_b64 s[66:67]
L_pc:
  s_lshr_b32 s62, s2, 3
  s_lshl_b32 s62, s62, 10
  v_lshrrev_b32 v244, 6, v0
  v_lshlrev_b32 v244, 8, v244
  v_and_b32 v1, 1, v0
  v_lshl_add_u32 v244, v1, 7, v244
  v_add_u32 v244, s62, v244
  v_min_u32 v244, (L_code_end - L_pc - 4), v244
  s_mov_b64 exec, 3
  global_load_dword v245, v244, s[66:67]
  s_mov_b64 exec, -1
  v_and_b32 v1, 63, v0
  v_lshrrev_b32 v216, 6, v0
  s_and_b32 s62, s2, 7
  s_lshr_b32 s63, s2, 3
  v_readfirstlane_b32 s22, v216
  s_lshr_b32 s64, s62, 1
  s_lshl_b32 s64, s64, 2
  s_lshr_b32 s65, s63, 3
  s_add_u32 s76, s64, s65
  s_and_b32 s64, s62, 1
  s_lshl_b32 s64, s64, 3
  s_and_b32 s65, s63, 7
  s_add_u32 s77, s64, s65
  s_mul_i32 s60, s76, 14
  s_sub_u32 s60, s60, 2
  s_mul_i32 s61, s77, 14
  s_sub_u32 s61, s61, 2
  v_mul_u32_u24 v216, 57, v1
  v_lshrrev_b32 v216, 10, v216
  v_mul_u32_u24 v217, 18, v216
  v_sub_u32 v217, v1, v217
  v_add_u32 v217, s61, v217
  s_mul_i32 s62, s22, 48
  v_mul_i32_i24 v218, 192, v217
  v_lshl_add_u32 v218, v216, 4, v218
  v_add_u32 v218, s62, v218
  v_mov_b32 v219, 0x80000000
  v_cmp_gt_u32 vcc, 224, v217
  s_nop 1
  v_cndmask_b32 v240, v219, v218, vcc
  v_add_u32 v246, 39424, v240
  v_mul_u32_u24 v216, 171, v1
  v_lshrrev_b32 v216, 9, v216
  v_mul_u32_u24 v217, 3, v216
  v_sub_u32 v217, v1, v217
  v_mul_u32_u24 v216, 192, v216
  v_lshl_add_u32 v216, v217, 4, v216
  v_add_u32 v220, s62, v216
  v_add_u32 v217, 64, v1
  v_mul_u32_u24 v216, 171, v217
  v_lshrrev_b32 v216, 9, v216
  v_mul_u32_u24 v218, 3, v216
  v_sub_u32 v218, v217, v218
  v_mul_u32_u24 v216, 192, v216
  v_lshl_add_u32 v216, v218, 4, v216
  v_add_u32 v216, s62, v216
  v_cmp_gt_u32 vcc, 75, v217
  s_nop 1
  v_cndmask_b32 v221, v219, v216, vcc
  s_lshr_b32 s100, s2, 3
  s_lshl_b32 s100, s100, 4
  s_and_b32 s101, s2, 3
  s_lshl_b32 s101, s101, 2
  s_add_u32 s100, s100, s101
  s_add_u32 s100, s100, s22
  s_bitcmp1_b32 s2, 2
  s_cselect_b32 s100, 1023, s100
  s_cmp_ge_u32 s100, 72
  s_cselect_b32 s96, 72, 0
  s_sub_u32 s101, s100, s96
  s_mul_i32 s96, s101, 3641
  s_lshr_b32 s96, s96, 16
  s_mul_i32 s97, s96, 18
  s_sub_u32 s97, s101, s97
  s_mul_i32 s68, s97, 43
  s_lshr_b32 s68, s68, 8
  s_mul_i32 s101, s68, 6
  s_sub_u32 s97, s97, s101
  s_cmp_ge_u32 s100, 72
  s_cbranch_scc1 L_pw2
  s_mul_i32 s101, s97, 12288
  s_mul_i32 s96, s96, 192
  s_add_u32 s101, s101, s96
  s_lshl_b32 s68, s68, 6
  s_add_u32 s101, s101, s68
  v_lshrrev_b32 v222, 5, v1
  v_mul_u32_u24 v222, 6144, v222
  v_and_b32 v223, 31, v1
  v_lshl_add_u32 v222, v223, 1, v222
  v_add_u32 v247, s101, v222
  s_branch L_pdone
L_pw2:
  s_mul_i32 s96, s96, 96
  s_lshl_b32 s68, s68, 5
  s_add_u32 s96, s96, s68
  s_mul_i32 s101, s96, 192
  s_lshr_b32 s68, s97, 1
  s_lshl_b32 s68, s68, 6
  s_add_u32 s101, s101, s68
  s_and_b32 s68, s97, 1
  s_lshl_b32 s68, s68, 3
  s_add_u32 s101, s101, s68
  s_cmp_ge_u32 s100, 144
  s_cselect_b32 s101, 2.0, s101
  v_lshrrev_b32 v222, 4, v1
  v_lshrrev_b32 v223, 1, v222
  v_lshlrev_b32 v223, 4, v223
  v_and_b32 v222, 1, v222
  v_lshl_add_u32 v223, v222, 2, v223
  v_mul_u32_u24 v223, 192, v223
  v_bfe_u32 v222, v1, 2, 2
  v_lshl_add_u32 v223, v222, 4, v223
  v_and_b32 v222, 3, v1
  v_lshl_add_u32 v223, v222, 1, v223
  v_add_u32 v247, s101, v223
L_pdone:
  s_mul_i32 s23, s22, 864
  s_mul_i32 s3, s60, 43008
  s_mul_i32 s63, s22, 1280
  s_add_u32 s63, s63, 64512
  s_add_u32 s64, s63, 1024
  s_waitcnt lgkmcnt(0)
  s_mov_b32 s28, s6
  s_and_b32 s29, s7, 0xffff
  s_mov_b32 s30, 0x000012c0
  s_mov_b32 s31, 0x20000
  s_mov_b32 s24, s4
  s_and_b32 s25, s5, 0xffff
  s_mov_b32 s26, 0x00930000
  s_mov_b32 s27, 0x20000
  s_mov_b32 m0, s63
  s_nop 0
  buffer_load_dwordx4 v220, s[28:31], 0 offen lds
  s_mov_b32 m0, s64
  s_mov_b32 exec_lo, 0xffff
  s_mov_b32 exec_hi, 0
  buffer_load_dwordx4 v221, s[28:31], 0 offen lds
  s_mov_b64 exec, -1
  s_mov_b32 s32, s8
  s_and_b32 s33, s9, 0xffff
  s_mov_b32 s34, 0x00012000
  s_mov_b32 s35, 0x20000
  s_mov_b32 s36, s10
  s_and_b32 s37, s11, 0xffff
  s_mov_b32 s38, 0x00012000
  s_mov_b32 s39, 0x20000
  s_mov_b32 s101, 3072
  s_cmp_ge_u32 s100, 72
  s_cbranch_scc1 L_pg2
  buffer_load_ushort v248, v247, s[32:35], 0 offen offset:0
  buffer_load_ushort v249, v247, s[32:35], 0 offen offset:768
  buffer_load_ushort v250, v247, s[32:35], 0 offen offset:1536
  buffer_load_ushort v251, v247, s[32:35], 0 offen offset:2304
  buffer_load_ushort v252, v247, s[32:35], s101 offen offset:0
  buffer_load_ushort v253, v247, s[32:35], s101 offen offset:768
  buffer_load_ushort v254, v247, s[32:35], s101 offen offset:1536
  buffer_load_ushort v255, v247, s[32:35], s101 offen offset:2304
  s_branch L_pg3
L_pg2:
  buffer_load_ushort v248, v247, s[36:39], 0 offen offset:0
  buffer_load_ushort v249, v247, s[36:39], 0 offen offset:192
  buffer_load_ushort v250, v247, s[36:39], 0 offen offset:384
  buffer_load_ushort v251, v247, s[36:39], 0 offen offset:576
  buffer_load_ushort v252, v247, s[36:39], 0 offen offset:1536
  buffer_load_ushort v253, v247, s[36:39], 0 offen offset:1728
  buffer_load_ushort v254, v247, s[36:39], 0 offen offset:1920
  buffer_load_ushort v255, v247, s[36:39], 0 offen offset:2112
L_pg3:
  s_mov_b64 exec, -1
  s_mov_b32 exec_hi, 0x003fffff
  s_mov_b32 m0, s23
  s_cmp_lt_i32 s3, 0
  s_cselect_b32 s65, 2.0, s3
  buffer_load_dwordx4 v240, s[24:27], s65 offen lds
  buffer_load_dwordx4 v246, s[24:27], s65 offen offset:3584 lds
  s_add_u32 s23, s23, 7168
  s_add_u32 s3, s3, 86016
  s_mov_b64 exec, -1
  v_and_b32 v216, 15, v1
  v_lshrrev_b32 v217, 4, v1
  v_and_b32 v218, 1, v217
  v_lshrrev_b32 v219, 1, v217
  v_lshrrev_b32 v223, 3, v216
  v_and_b32 v224, 7, v216
  s_mul_i32 s63, s22, 1280
  s_add_u32 s63, s63, 64512
  v_lshl_add_u32 v224, v224, 1, s63
  v_sub_u32 v225, v219, v223
  v_mul_i32_i24 v220, 5, v225
  v_lshl_add_u32 v220, v218, 1, v220
  v_mul_i32_i24 v220, 48, v220
  v_add_u32 v22, v224, v220
  v_lshlrev_b32 v226, 1, v217
  v_sub_u32 v226, v226, v223
  v_mul_i32_i24 v220, 240, v226
  v_add_u32 v220, v224, v220
  v_add_u32 v23, 192, v220
  v_and_b32 v220, 3, v216
  v_mul_u32_u24 v80, 0x5555, v220
  s_mov_b32 s70, 0x0f0f0f0f
  s_mov_b32 s71, 0x0f0f0f0f
  s_mov_b32 exec_hi, 0x003fffff
  s_mov_b32 m0, s23
  s_nop 0
  buffer_load_dwordx4 v240, s[24:27], s3 offen lds
  buffer_load_dwordx4 v246, s[24:27], s3 offen offset:3584 lds
  s_add_u32 s23, s23, 7168
  s_add_u32 s3, s3, 86016
  s_mov_b64 exec, -1
  v_mov_b32 v82, 163584
  s_lshl_b32 s62, s22, 2
  v_add_u32 v81, s62, v82
  v_mov_b32 v227, 0
  s_mov_b64 exec, 1
  ds_write_b32 v81, v227
  ds_write_b32 v81, v227 offset:16
  s_mov_b64 exec, -1
  s_waitcnt vmcnt(12)
  ds_read_u16 v84, v22 offset:0
  ds_read_u16 v85, v22 offset:48
  ds_read_u16 v86, v22 offset:480
  ds_read_u16 v87, v22 offset:528
  ds_read_u16 v88, v22 offset:960
  ds_read_u16 v89, v22 offset:1008
  ds_read_u16 v90, v23 offset:0
  ds_read_u16 v91, v23 offset:240
  ds_read_u16 v92, v22 offset:16
  ds_read_u16 v93, v22 offset:64
  ds_read_u16 v94, v22 offset:496
  ds_read_u16 v95, v22 offset:544
  ds_read_u16 v96, v22 offset:976
  ds_read_u16 v97, v22 offset:1024
  ds_read_u16 v98, v23 offset:16
  ds_read_u16 v99, v23 offset:256
  ds_read_u16 v100, v22 offset:32
  ds_read_u16 v101, v22 offset:80
  ds_read_u16 v102, v22 offset:512
  ds_read_u16 v103, v22 offset:560
  ds_read_u16 v104, v22 offset:992
  ds_read_u16 v105, v22 offset:1040
  ds_read_u16 v106, v23 offset:32
  ds_read_u16 v107, v23 offset:272
  s_mov_b32 exec_hi, 0x003fffff
  s_mov_b32 m0, s23
  s_nop 0
  buffer_load_dwordx4 v240, s[24:27], s3 offen lds
  buffer_load_dwordx4 v246, s[24:27], s3 offen offset:3584 lds
  s_add_u32 s23, s23, 7168
  s_add_u32 s3, s3, 86016
  s_mov_b64 exec, -1
  s_mul_i32 s62, s22, 864
  v_add_u32 v220, v216, v217
  v_lshlrev_b32 v220, 4, v220
  v_add_u32 v16, s62, v220
  v_add_u32 v221, 4, v216
  v_lshlrev_b32 v221, 4, v221
  v_add_u32 v221, s62, v221
  v_mul_u32_u24 v220, 3584, v217
  v_add_u32 v17, v220, v221
  v_add_u32 v220, 4, v218
  v_mul_u32_u24 v220, 3584, v220
  v_add_u32 v18, v220, v221
  v_lshl_add_u32 v220, v219, 4, v216
  s_mov_b32 exec_hi, 0x003fffff
  s_mov_b32 m0, s23
  s_nop 0
  buffer_load_dwordx4 v240, s[24:27], s3 offen lds
  buffer_load_dwordx4 v246, s[24:27], s3 offen offset:3584 lds
  s_add_u32 s23, s23, 7168
  s_add_u32 s3, s3, 86016
  s_mov_b64 exec, -1
  v_lshlrev_b32 v220, 6, v220
  v_add_u32 v20, 143360, v220
  s_lshl_b32 s63, s22, 4
  v_lshl_add_u32 v220, v218, 3, v20
  v_add_u32 v19, s63, v220
  v_mul_u32_u24 v220, 14, v219
  v_add_u32 v220, v220, v216
  v_mul_u32_u24 v220, 208, v220
  v_lshl_add_u32 v220, v218, 3, v220
  s_mul_i32 s63, s22, 48
  v_add_u32 v21, s63, v220
  s_mov_b32 s72, 0x3fff3fff
  s_mov_b32 s73, 0x3fff3fff
  s_mov_b32 s44, s20
  s_and_b32 s45, s21, 0xffff
  s_mov_b32 s46, 0x00200000
  s_mov_b32 s47, 0x20000
  s_mov_b32 s48, s18
  s_and_b32 s49, s19, 0xffff
  s_mov_b32 s50, 0x00000100
  s_mov_b32 s51, 0x20000
  s_mov_b32 s40, s16
  s_and_b32 s41, s17, 0xffff
  s_mov_b32 s42, 0x00930000
  s_mov_b32 s43, 0x20000
  s_mov_b32 s52, s12
  s_and_b32 s53, s13, 0xffff
  s_mov_b32 s54, 0x00000300
  s_mov_b32 s55, 0x20000
  s_mov_b32 s56, s14
  s_and_b32 s57, s15, 0xffff
  s_mov_b32 s58, 0x00000300
  s_mov_b32 s59, 0x20000
  s_waitcnt vmcnt(8)
  v_lshl_or_b32 v248, v249, 16, v248
  v_lshl_or_b32 v249, v251, 16, v250
  v_lshl_or_b32 v250, v253, 16, v252
  v_lshl_or_b32 v251, v255, 16, v254
  s_lshl_b32 s97, s100, 10
  s_cmp_ge_u32 s100, 72
  s_cselect_b32 s101, 24576, 0
  s_add_u32 s97, s97, s101
  s_add_u32 s97, s97, 786432
  s_cmp_ge_u32 s100, 144
  s_cselect_b32 s97, 2.0, s97
  v_lshlrev_b32 v83, 4, v1
  buffer_store_dwordx4 v[248:251], v83, s[44:47], s97 offen sc1
  s_waitcnt lgkmcnt(0)
  s_barrier
  v_cmp_le_i32 vcc, 0, v225
  s_nop 3
  s_and_b64 s[62:63], vcc, s[70:71]
  s_andn2_b64 s[64:65], vcc, s[70:71]
  v_cndmask_b32 v32, 0, v84, s[62:63]
  v_cndmask_b32 v33, 0, v84, s[64:65]
  v_cndmask_b32 v48, 0, v92, s[62:63]
  v_cndmask_b32 v49, 0, v92, s[64:65]
  v_cndmask_b32 v64, 0, v100, s[62:63]
  v_cndmask_b32 v65, 0, v100, s[64:65]
  v_cndmask_b32 v34, 0, v85, s[62:63]
  v_cndmask_b32 v35, 0, v85, s[64:65]
  v_cndmask_b32 v50, 0, v93, s[62:63]
  v_cndmask_b32 v51, 0, v93, s[64:65]
  v_cndmask_b32 v66, 0, v101, s[62:63]
  v_cndmask_b32 v67, 0, v101, s[64:65]
  s_mov_b64 s[62:63], s[70:71]
  s_not_b64 s[64:65], s[70:71]
  v_cndmask_b32 v36, 0, v86, s[62:63]
  v_cndmask_b32 v37, 0, v86, s[64:65]
  v_cndmask_b32 v52, 0, v94, s[62:63]
  v_cndmask_b32 v53, 0, v94, s[64:65]
  v_cndmask_b32 v68, 0, v102, s[62:63]
  v_cndmask_b32 v69, 0, v102, s[64:65]
  v_cndmask_b32 v38, 0, v87, s[62:63]
  v_cndmask_b32 v39, 0, v87, s[64:65]
  v_cndmask_b32 v54, 0, v95, s[62:63]
  v_cndmask_b32 v55, 0, v95, s[64:65]
  v_cndmask_b32 v70, 0, v103, s[62:63]
  v_cndmask_b32 v71, 0, v103, s[64:65]
  v_cmp_ge_i32 vcc, 0, v225
  s_nop 3
  s_and_b64 s[62:63], vcc, s[70:71]
  s_andn2_b64 s[64:65], vcc, s[70:71]
  v_cndmask_b32 v40, 0, v88, s[62:63]
  v_cndmask_b32 v41, 0, v88, s[64:65]
  v_cndmask_b32 v56, 0, v96, s[62:63]
  v_cndmask_b32 v57, 0, v96, s[64:65]
  v_cndmask_b32 v72, 0, v104, s[62:63]
  v_cndmask_b32 v73, 0, v104, s[64:65]
  v_cndmask_b32 v42, 0, v89, s[62:63]
  v_cndmask_b32 v43, 0, v89, s[64:65]
  v_cndmask_b32 v58, 0, v97, s[62:63]
  v_cndmask_b32 v59, 0, v97, s[64:65]
  v_cndmask_b32 v74, 0, v105, s[62:63]
  v_cndmask_b32 v75, 0, v105, s[64:65]
  v_cmp_gt_u32 vcc, 5, v226
  s_nop 3
  s_and_b64 s[62:63], vcc, s[70:71]
  s_andn2_b64 s[64:65], vcc, s[70:71]
  v_cndmask_b32 v44, 0, v90, s[62:63]
  v_cndmask_b32 v45, 0, v90, s[64:65]
  v_cndmask_b32 v60, 0, v98, s[62:63]
  v_cndmask_b32 v61, 0, v98, s[64:65]
  v_cndmask_b32 v76, 0, v106, s[62:63]
  v_cndmask_b32 v77, 0, v106, s[64:65]
  v_add_u32 v226, 1, v226
  v_cmp_gt_u32 vcc, 5, v226
  s_nop 3
  s_and_b64 s[62:63], vcc, s[70:71]
  s_andn2_b64 s[64:65], vcc, s[70:71]
  v_cndmask_b32 v46, 0, v91, s[62:63]
  v_cndmask_b32 v47, 0, v91, s[64:65]
  v_cndmask_b32 v62, 0, v99, s[62:63]
  v_cndmask_b32 v63, 0, v99, s[64:65]
  v_cndmask_b32 v78, 0, v107, s[62:63]
  v_cndmask_b32 v79, 0, v107, s[64:65]
  s_mov_b32 s4, 0x3c2aaaab
  s_mov_b32 s5, 0x3c2aaaab
  s_mov_b32 s6, 0x3727c5ac
  s_mov_b32 s7, 0x3727c5ac
  s_mov_b32 s8, 0xbeeff558
  s_mov_b32 s9, 0xbeeff558
  v_mov_b64 v[132:133], 0
  v_mov_b64 v[134:135], 0
  v_mov_b64 v[136:137], 0
  v_mov_b64 v[138:139], 0
  v_mov_b64 v[140:141], 0
  v_mov_b64 v[142:143], 0
  s_waitcnt vmcnt(7)
  ds_read_b128 a[0:3], v16 offset:0
  ds_read_b128 a[4:7], v16 offset:3584
  ds_read_b128 a[8:11], v16 offset:288
  ds_read_b128 a[12:15], v16 offset:3872
  ds_read_b128 a[16:19], v16 offset:576
  ds_read_b128 a[20:23], v16 offset:4160
  s_waitcnt vmcnt(5)
  s_waitcnt lgkmcnt(4)
  v_smfmac_f32_16x16x64_bf16 v[132:135], v[32:35], a[0:7], v80
  ds_read_b128 a[48:51], v16 offset:7168
  ds_read_b128 a[52:55], v16 offset:10752
  s_waitcnt lgkmcnt(4)
  v_smfmac_f32_16x16x64_bf16 v[136:139], v[48:51], a[8:15], v80
  ds_read_b128 a[56:59], v16 offset:7456
  ds_read_b128 a[60:63], v16 offset:11040
  s_waitcnt lgkmcnt(4)
  v_smfmac_f32_16x16x64_bf16 v[140:143], v[64:67], a[16:23], v80
  ds_read_b128 a[64:67], v16 offset:7744
  ds_read_b128 a[68:71], v16 offset:11328
  s_mov_b32 exec_hi, 0x003fffff
  s_mov_b32 m0, s23
  s_nop 0
  buffer_load_dwordx4 v240, s[24:27], s3 offen lds
  buffer_load_dwordx4 v246, s[24:27], s3 offen offset:3584 lds
  s_add_u32 s23, s23, 7168
  s_add_u32 s3, s3, 86016
  s_mov_b64 exec, -1
  v_mov_b64 v[144:145], 0
  v_mov_b64 v[146:147], 0
  v_mov_b64 v[148:149], 0
  v_mov_b64 v[150:151], 0
  v_mov_b64 v[152:153], 0
  v_mov_b64 v[154:155], 0
  v_and_b32 v228, 31, v1
  v_lshrrev_b32 v229, 5, v1
  v_and_b32 v230, 0x13, v228
  v_and_b32 v231, 4, v228
  v_lshl_or_b32 v230, v231, 1, v230
  v_and_b32 v231, 8, v228
  v_lshrrev_b32 v231, 1, v231
  v_or_b32 v230, v230, v231
  v_mul_u32_u24 v230, 208, v230
  v_lshl_add_u32 v2, v229, 4, v230
  v_bfe_u32 v230, v228, 2, 1
  v_and_b32 v231, 1, v228
  v_lshl_add_u32 v230, v230, 1, v231
  v_add_u32 v230, 192, v230
  v_mul_u32_u24 v230, 208, v230
  v_lshl_add_u32 v3, v229, 4, v230
  s_mul_i32 s62, s22, 12288
  s_add_u32 s62, s62, 40960
  v_lshlrev_b32 v230, 7, v228
  v_add_u32 v230, s62, v230
  v_and_b32 v231, 7, v228
  v_xor_b32 v231, v231, v229
  v_xor_b32 v232, 0, v231
  v_lshl_add_u32 v4, v232, 4, v230
  v_xor_b32 v232, 2, v231
  v_lshl_add_u32 v5, v232, 4, v230
  v_xor_b32 v232, 4, v231
  v_lshl_add_u32 v6, v232, 4, v230
  v_xor_b32 v232, 6, v231
  v_lshl_add_u32 v7, v232, 4, v230
  s_mul_i32 s62, s22, 768
  v_lshlrev_b32 v230, 3, v228
  v_lshl_add_u32 v230, v229, 2, v230
  v_add_u32 v10, s62, v230
  v_lshrrev_b32 v228, 4, v1
  v_bfe_u32 v229, v1, 2, 2
  v_and_b32 v233, 3, v1
  v_lshrrev_b32 v230, 1, v228
  v_lshlrev_b32 v230, 4, v230
  v_and_b32 v231, 1, v228
  v_lshl_add_u32 v231, v231, 2, v229
  v_add_u32 v230, v230, v231
  v_lshlrev_b32 v11, 3, v230
  s_lshl_b32 s62, s22, 1
  v_lshrrev_b32 v232, 1, v233
  v_add_u32 v232, s62, v232
  v_xor_b32 v232, v232, v231
  v_lshlrev_b32 v230, 7, v230
  v_lshl_add_u32 v230, v232, 4, v230
  v_and_b32 v232, 1, v233
  v_lshl_add_u32 v230, v232, 3, v230
  v_add_u32 v8, 40960, v230
  v_add_u32 v9, 90112, v230
  s_mov_b32 s74, 0x409d30fc
  s_mov_b32 s75, 0x409d30fc
  v_and_b32 v229, 15, v1
  s_mul_i32 s64, s76, 14
  s_mul_i32 s65, s77, 14
  s_mul_i32 s64, s64, 224
  s_add_u32 s64, s64, s65
  s_mul_i32 s64, s64, 192
  s_lshl_b32 s65, s22, 4
  v_add_u32 v230, s65, v229
  v_mul_u32_u24 v231, 4682, v230
  v_lshrrev_b32 v231, 16, v231
  v_mul_u32_u24 v232, 14, v231
  v_sub_u32 v232, v230, v232
  v_mul_u32_u24 v231, 224, v231
  v_add_u32 v231, v231, v232
  v_mul_u32_u24 v231, 192, v231
  v_lshl_add_u32 v231, v228, 4, v231
  v_add_u32 v12, s64, v231
  v_add_u32 v230, s65, v229
  v_add_u32 v230, 64, v230
  v_mul_u32_u24 v231, 4682, v230
  v_lshrrev_b32 v231, 16, v231
  v_mul_u32_u24 v232, 14, v231
  v_sub_u32 v232, v230, v232
  v_mul_u32_u24 v231, 224, v231
  v_add_u32 v231, v231, v232
  v_mul_u32_u24 v231, 192, v231
  v_lshl_add_u32 v231, v228, 4, v231
  v_add_u32 v13, s64, v231
  v_add_u32 v230, s65, v229
  v_add_u32 v230, 128, v230
  v_mul_u32_u24 v231, 4682, v230
  v_lshrrev_b32 v231, 16, v231
  v_mul_u32_u24 v232, 14, v231
  v_sub_u32 v232, v230, v232
  v_mul_u32_u24 v231, 224, v231
  v_add_u32 v231, v231, v232
  v_mul_u32_u24 v231, 192, v231
  v_lshl_add_u32 v231, v228, 4, v231
  v_add_u32 v14, s64, v231
  v_and_b32 v230, 3, v229
  v_add_u32 v230, 192, v230
  v_mul_u32_u24 v231, 4682, v230
  v_lshrrev_b32 v231, 16, v231
  v_mul_u32_u24 v232, 14, v231
  v_sub_u32 v232, v230, v232
  v_mul_u32_u24 v231, 224, v231
  v_add_u32 v231, v231, v232
  v_mul_u32_u24 v231, 192, v231
  v_lshl_add_u32 v231, v228, 4, v231
  v_add_u32 v15, s64, v231
  s_min_u32 s79, s22, 2
  s_lshl_b32 s67, s79, 6
  v_add_u32 v15, s67, v15
  v_and_b32 v31, 3, v1
  v_lshlrev_b32 v31, 6, v31
  s_waitcnt vmcnt(2)
  s_and_b32 s97, s100, 3
  s_lshl_b32 s97, s97, 6
  s_add_u32 s97, s97, 8
  s_cmp_ge_u32 s100, 144
  s_cselect_b32 s97, 2.0, s97
  v_mov_b32 v83, s97
  v_mov_b32 v247, 1
  s_mov_b64 exec, 1
  buffer_atomic_add v247, v83, s[48:51], 0 offen
  s_mov_b64 exec, -1
  s_waitcnt lgkmcnt(4)
  v_smfmac_f32_16x16x64_bf16 v[144:147], v[32:35], a[48:55], v80
  ds_read_b128 a[0:3], v16 offset:14336
  ds_read_b128 a[4:7], v16 offset:17920
  v_smfmac_f32_16x16x64_bf16 v[132:135], v[36:39], a[48:55], v80
  ds_read_b128 a[8:11], v16 offset:14624
  ds_read_b128 a[12:15], v16 offset:18208
  s_waitcnt lgkmcnt(6)
  v_smfmac_f32_16x16x64_bf16 v[148:151], v[48:51], a[56:63], v80
  ds_read_b128 a[16:19], v16 offset:14912
  ds_read_b128 a[20:23], v16 offset:18496
  v_smfmac_f32_16x16x64_bf16 v[136:139], v[52:55], a[56:63], v80
  ds_read_b128 a[24:27], v17 offset:0
  ds_read_b128 a[28:31], v18 offset:0
  s_waitcnt lgkmcnt(8)
  v_smfmac_f32_16x16x64_bf16 v[152:155], v[64:67], a[64:71], v80
  ds_read_b128 a[32:35], v17 offset:288
  ds_read_b128 a[36:39], v18 offset:288
  v_smfmac_f32_16x16x64_bf16 v[140:143], v[68:71], a[64:71], v80
  ds_read_b128 a[40:43], v17 offset:576
  ds_read_b128 a[44:47], v18 offset:576
  s_mov_b32 exec_hi, 0x003fffff
  s_mov_b32 m0, s23
  s_nop 0
  buffer_load_dwordx4 v240, s[24:27], s3 offen lds
  buffer_load_dwordx4 v246, s[24:27], s3 offen offset:3584 lds
  s_add_u32 s23, s23, 7168
  s_add_u32 s3, s3, 86016
  s_mov_b64 exec, -1
  v_mov_b64 v[156:157], 0
  v_mov_b64 v[158:159], 0
  v_mov_b64 v[160:161], 0
  v_mov_b64 v[162:163], 0
  v_mov_b64 v[164:165], 0
  v_mov_b64 v[166:167], 0
  v_lshlrev_b32 v23, 4, v1
  v_lshrrev_b32 v232, 4, v1
  v_lshrrev_b32 v233, 1, v232
  v_lshlrev_b32 v233, 4, v233
  v_and_b32 v235, 1, v232
  v_lshl_add_u32 v233, v235, 2, v233
  s_mul_i32 s65, s22, 96
  v_add_u32 v234, s65, v233
  v_lshlrev_b32 v28, 1, v234
  v_lshlrev_b32 v24, 2, v234
  v_add_u32 v24, 73728, v24
  v_bfe_u32 v235, v1, 2, 2
  v_add_u32 v233, v233, v235
  v_mul_u32_u24 v233, 192, v233
  v_and_b32 v235, 3, v1
  v_lshl_add_u32 v233, v235, 4, v233
  s_mul_i32 s62, s22, 6144
  s_add_u32 s10, s62, 139264
  v_add_u32 v25, s10, v233
  s_add_u32 s12, s10, 4096
  s_mul_i32 s11, s22, 18432
  s_add_u32 s11, s11, 884736
  s_add_u32 s13, s11, 4096
  s_and_b32 s62, s2, 15
  s_mul_i32 s62, s62, 1536
  s_add_u32 s69, s62, 524288
  v_min_u32 v27, 31, v1
  v_lshlrev_b32 v27, 4, v27
  v_add_u32 v27, s69, v27
  v_lshlrev_b32 v26, 5, v232
  s_waitcnt lgkmcnt(10)
  v_smfmac_f32_16x16x64_bf16 v[156:159], v[32:35], a[0:7], v80
  ds_read_b128 a[48:51], v16 offset:21504
  v_smfmac_f32_16x16x64_bf16 v[144:147], v[36:39], a[0:7], v80
  ds_read_b128 a[52:55], v16 offset:25088
  v_smfmac_f32_16x16x64_bf16 v[132:135], v[40:43], a[0:7], v80
  ds_read_b128 a[56:59], v16 offset:21792
  s_waitcnt lgkmcnt(11)
  v_smfmac_f32_16x16x64_bf16 v[160:163], v[48:51], a[8:15], v80
  ds_read_b128 a[60:63], v16 offset:25376
  v_smfmac_f32_16x16x64_bf16 v[148:151], v[52:55], a[8:15], v80
  ds_read_b128 a[64:67], v16 offset:22080
  v_smfmac_f32_16x16x64_bf16 v[136:139], v[56:59], a[8:15], v80
  ds_read_b128 a[68:71], v16 offset:25664
  s_waitcnt lgkmcnt(12)
  v_smfmac_f32_16x16x64_bf16 v[164:167], v[64:67], a[16:23], v80
  ds_read_b128 a[72:75], v17 offset:7168
  v_smfmac_f32_16x16x64_bf16 v[152:155], v[68:71], a[16:23], v80
  ds_read_b128 a[76:79], v18 offset:7168
  v_smfmac_f32_16x16x64_bf16 v[140:143], v[72:75], a[16:23], v80
  ds_read_b128 a[80:83], v17 offset:7456
  s_waitcnt lgkmcnt(13)
  v_smfmac_f32_16x16x64_bf16 v[132:135], v[44:47], a[24:31], v80
  ds_read_b128 a[84:87], v18 offset:7456
  s_waitcnt lgkmcnt(12)
  v_smfmac_f32_16x16x64_bf16 v[136:139], v[60:63], a[32:39], v80
  ds_read_b128 a[88:91], v17 offset:7744
  s_waitcnt lgkmcnt(11)
  v_smfmac_f32_16x16x64_bf16 v[140:143], v[76:79], a[40:47], v80
  ds_read_b128 a[92:95], v18 offset:7744
  s_mov_b32 exec_hi, 0x003fffff
  s_mov_b32 m0, s23
  s_nop 0
  buffer_load_dwordx4 v240, s[24:27], s3 offen lds
  buffer_load_dwordx4 v246, s[24:27], s3 offen offset:3584 lds
  s_add_u32 s23, s23, 7168
  s_add_u32 s3, s3, 86016
  s_mov_b64 exec, -1
  v_mov_b64 v[168:169], 0
  v_mov_b64 v[170:171], 0
  v_mov_b64 v[172:173], 0
  v_mov_b64 v[174:175], 0
  v_mov_b64 v[176:177], 0
  v_mov_b64 v[178:179], 0
  v_pk_add_f32 v[216:217], v[132:133], v[134:135]
  v_pk_mul_f32 v[218:219], v[132:133], v[132:133]
  v_pk_fma_f32 v[218:219], v[134:135], v[134:135], v[218:219]
  v_pk_add_f32 v[216:217], v[216:217], v[136:137]
  v_pk_fma_f32 v[218:219], v[136:137], v[136:137], v[218:219]
  v_pk_add_f32 v[216:217], v[216:217], v[138:139]
  v_pk_fma_f32 v[218:219], v[138:139], v[138:139], v[218:219]
  v_pk_add_f32 v[216:217], v[216:217], v[140:141]
  v_pk_fma_f32 v[218:219], v[140:141], v[140:141], v[218:219]
  v_pk_add_f32 v[216:217], v[216:217], v[142:143]
  v_pk_fma_f32 v[218:219], v[142:143], v[142:143], v[218:219]
  v_add_f32 v216, v216, v217
  v_add_f32 v218, v218, v219
  s_nop 1
  v_permlane16_swap_b32 v216, v218
  v_add_f32 v216, v216, v218
  ds_write_b32 v19, v216 offset:0
  s_waitcnt vmcnt(5)
  s_waitcnt lgkmcnt(11)
  v_smfmac_f32_16x16x64_bf16 v[168:171], v[32:35], a[48:55], v80
  ds_read_b128 a[0:3], v16 offset:28672
  v_smfmac_f32_16x16x64_bf16 v[156:159], v[36:39], a[48:55], v80
  ds_read_b128 a[4:7], v16 offset:32256
  v_smfmac_f32_16x16x64_bf16 v[144:147], v[40:43], a[48:55], v80
  ds_read_b128 a[8:11], v16 offset:28960
  s_waitcnt lgkmcnt(12)
  v_smfmac_f32_16x16x64_bf16 v[172:175], v[48:51], a[56:63], v80
  ds_read_b128 a[12:15], v16 offset:32544
  v_smfmac_f32_16x16x64_bf16 v[160:163], v[52:55], a[56:63], v80
  ds_read_b128 a[16:19], v16 offset:29248
  v_smfmac_f32_16x16x64_bf16 v[148:151], v[56:59], a[56:63], v80
  ds_read_b128 a[20:23], v16 offset:32832
  s_waitcnt lgkmcnt(13)
  v_smfmac_f32_16x16x64_bf16 v[176:179], v[64:67], a[64:71], v80
  ds_read_b128 a[24:27], v17 offset:14336
  v_smfmac_f32_16x16x64_bf16 v[164:167], v[68:71], a[64:71], v80
  ds_read_b128 a[28:31], v18 offset:14336
  v_smfmac_f32_16x16x64_bf16 v[152:155], v[72:75], a[64:71], v80
  ds_read_b128 a[32:35], v17 offset:14624
  s_waitcnt lgkmcnt(14)
  v_smfmac_f32_16x16x64_bf16 v[144:147], v[44:47], a[72:79], v80
  ds_read_b128 a[36:39], v18 offset:14624
  s_waitcnt lgkmcnt(13)
  v_smfmac_f32_16x16x64_bf16 v[148:151], v[60:63], a[80:87], v80
  ds_read_b128 a[40:43], v17 offset:14912
  s_waitcnt lgkmcnt(12)
  v_smfmac_f32_16x16x64_bf16 v[152:155], v[76:79], a[88:95], v80
  ds_read_b128 a[44:47], v18 offset:14912
  s_mov_b32 exec_hi, 0x003fffff
  s_mov_b32 m0, s23
  s_nop 0
  buffer_load_dwordx4 v240, s[24:27], s3 offen lds
  buffer_load_dwordx4 v246, s[24:27], s3 offen offset:3584 lds
  s_add_u32 s23, s23, 7168
  s_add_u32 s3, s3, 86016
  s_mov_b64 exec, -1
  v_mov_b64 v[180:181], 0
  v_mov_b64 v[182:183], 0
  v_mov_b64 v[184:185], 0
  v_mov_b64 v[186:187], 0
  v_mov_b64 v[188:189], 0
  v_mov_b64 v[190:191], 0
  v_pk_add_f32 v[216:217], v[144:145], v[146:147]
  v_pk_mul_f32 v[218:219], v[144:145], v[144:145]
  v_pk_fma_f32 v[218:219], v[146:147], v[146:147], v[218:219]
  v_pk_add_f32 v[216:217], v[216:217], v[148:149]
  v_pk_fma_f32 v[218:219], v[148:149], v[148:149], v[218:219]
  v_pk_add_f32 v[216:217], v[216:217], v[150:151]
  v_pk_fma_f32 v[218:219], v[150:151], v[150:151], v[218:219]
  v_pk_add_f32 v[216:217], v[216:217], v[152:153]
  v_pk_fma_f32 v[218:219], v[152:153], v[152:153], v[218:219]
  v_pk_add_f32 v[216:217], v[216:217], v[154:155]
  v_pk_fma_f32 v[218:219], v[154:155], v[154:155], v[218:219]
  v_add_f32 v216, v216, v217
  v_add_f32 v218, v218, v219
  s_nop 1
  v_permlane16_swap_b32 v216, v218
  v_add_f32 v216, v216, v218
  ds_write_b32 v19, v216 offset:4
  v_mov_b32 v220, 3
  s_mov_b64 exec, 1
  ds_write_b32 v81, v220
  s_mov_b64 exec, -1
  v_mov_b32 v248, -1
  v_mov_b32 v249, -1
  v_mov_b32 v250, -1
  v_mov_b32 v251, -1
  s_mul_i32 s63, s2, 1536
  s_mul_i32 s64, s22, 384
  s_add_u32 s63, s63, s64
  v_lshlrev_b32 v252, 4, v1
  v_add_u32 v252, s63, v252
  s_mov_b32 exec_lo, 0x00ffffff
  s_mov_b32 exec_hi, 0
  buffer_store_dwordx4 v[248:251], v252, s[44:47], 0 offen sc1
  s_cmp_ge_u32 s2, 16
  s_cselect_b32 s63, 2.0, 524288
  buffer_store_dwordx4 v[248:251], v252, s[44:47], s63 offen sc1
  s_mov_b64 exec, -1
  s_waitcnt vmcnt(6)
  s_waitcnt lgkmcnt(12)
  v_smfmac_f32_16x16x64_bf16 v[180:183], v[32:35], a[0:7], v80
  ds_read_b128 a[48:51], v16 offset:35840
  v_smfmac_f32_16x16x64_bf16 v[168:171], v[36:39], a[0:7], v80
  ds_read_b128 a[52:55], v16 offset:39424
  v_smfmac_f32_16x16x64_bf16 v[156:159], v[40:43], a[0:7], v80
  ds_read_b128 a[56:59], v16 offset:36128
  s_waitcnt lgkmcnt(13)
  v_smfmac_f32_16x16x64_bf16 v[184:187], v[48:51], a[8:15], v80
  ds_read_b128 a[60:63], v16 offset:39712
  v_smfmac_f32_16x16x64_bf16 v[172:175], v[52:55], a[8:15], v80
  ds_read_b128 a[64:67], v16 offset:36416
  v_smfmac_f32_16x16x64_bf16 v[160:163], v[56:59], a[8:15], v80
  ds_read_b128 a[68:71], v16 offset:40000
  s_waitcnt lgkmcnt(14)
  v_smfmac_f32_16x16x64_bf16 v[188:191], v[64:67], a[16:23], v80
  ds_read_b128 a[72:75], v17 offset:21504
  v_smfmac_f32_16x16x64_bf16 v[176:179], v[68:71], a[16:23], v80
  ds_read_b128 a[76:79], v18 offset:21504
  v_smfmac_f32_16x16x64_bf16 v[164:167], v[72:75], a[16:23], v80
  ds_read_b128 a[80:83], v17 offset:21792
  s_waitcnt lgkmcnt(15)
  v_smfmac_f32_16x16x64_bf16 v[156:159], v[44:47], a[24:31], v80
  ds_read_b128 a[84:87], v18 offset:21792
  s_waitcnt lgkmcnt(14)
  v_smfmac_f32_16x16x64_bf16 v[160:163], v[60:63], a[32:39], v80
  ds_read_b128 a[88:91], v17 offset:22080
  s_waitcnt lgkmcnt(13)
  v_smfmac_f32_16x16x64_bf16 v[164:167], v[76:79], a[40:47], v80
  ds_read_b128 a[92:95], v18 offset:22080
  s_mov_b32 exec_hi, 0x003fffff
  s_mov_b32 m0, s23
  s_nop 0
  buffer_load_dwordx4 v240, s[24:27], s3 offen lds
  buffer_load_dwordx4 v246, s[24:27], s3 offen offset:3584 lds
  s_mov_b64 exec, -1
  v_mov_b64 v[192:193], 0
  v_mov_b64 v[194:195], 0
  v_mov_b64 v[196:197], 0
  v_mov_b64 v[198:199], 0
  v_mov_b64 v[200:201], 0
  v_mov_b64 v[202:203], 0
  v_pk_add_f32 v[216:217], v[156:157], v[158:159]
  v_pk_mul_f32 v[218:219], v[156:157], v[156:157]
  v_pk_fma_f32 v[218:219], v[158:159], v[158:159], v[218:219]
  v_pk_add_f32 v[216:217], v[216:217], v[160:161]
  v_pk_fma_f32 v[218:219], v[160:161], v[160:161], v[218:219]
  v_pk_add_f32 v[216:217], v[216:217], v[162:163]
  v_pk_fma_f32 v[218:219], v[162:163], v[162:163], v[218:219]
  v_pk_add_f32 v[216:217], v[216:217], v[164:165]
  v_pk_fma_f32 v[218:219], v[164:165], v[164:165], v[218:219]
  v_pk_add_f32 v[216:217], v[216:217], v[166:167]
  v_pk_fma_f32 v[218:219], v[166:167], v[166:167], v[218:219]
  v_add_f32 v216, v216, v217
  v_add_f32 v218, v218, v219
  s_nop 1
  v_permlane16_swap_b32 v216, v218
  v_add_f32 v216, v216, v218
  ds_read_b128 v[224:227], v82
  ds_write_b32 v19, v216 offset:2048
  s_waitcnt lgkmcnt(1)
  v_min_u32 v224, v224, v225
  v_min3_u32 v224, v224, v226, v227
  v_cmp_gt_u32 vcc, 3, v224
  s_cbranch_vccz L_cf3_ok
L_cf3:
  ds_read_b128 v[224:227], v82
  s_waitcnt lgkmcnt(0)
  v_min_u32 v224, v224, v225
  v_min3_u32 v224, v224, v226, v227
  v_cmp_gt_u32 vcc, 3, v224
  s_cbranch_vccnz L_cf3
L_cf3_ok:
  ds_read_b128 v[224:227], v20 offset:0
  ds_read_b128 v[228:231], v20 offset:16
  ds_read_b128 v[232:235], v20 offset:32
  ds_read_b128 v[236:239], v20 offset:48
  s_waitcnt vmcnt(6)
  v_smfmac_f32_16x16x64_bf16 v[192:195], v[32:35], a[48:55], v80
  ds_read_b128 a[0:3], v16 offset:43008
  v_smfmac_f32_16x16x64_bf16 v[180:183], v[36:39], a[48:55], v80
  ds_read_b128 a[4:7], v16 offset:46592
  v_smfmac_f32_16x16x64_bf16 v[168:171], v[40:43], a[48:55], v80
  ds_read_b128 a[8:11], v16 offset:43296
  v_smfmac_f32_16x16x64_bf16 v[196:199], v[48:51], a[56:63], v80
  ds_read_b128 a[12:15], v16 offset:46880
  v_smfmac_f32_16x16x64_bf16 v[184:187], v[52:55], a[56:63], v80
  ds_read_b128 a[16:19], v16 offset:43584
  v_smfmac_f32_16x16x64_bf16 v[172:175], v[56:59], a[56:63], v80
  ds_read_b128 a[20:23], v16 offset:47168
  v_smfmac_f32_16x16x64_bf16 v[200:203], v[64:67], a[64:71], v80
  ds_read_b128 a[24:27], v17 offset:28672
  v_smfmac_f32_16x16x64_bf16 v[188:191], v[68:71], a[64:71], v80
  ds_read_b128 a[28:31], v18 offset:28672
  v_smfmac_f32_16x16x64_bf16 v[176:179], v[72:75], a[64:71], v80
  ds_read_b128 a[32:35], v17 offset:28960
  v_smfmac_f32_16x16x64_bf16 v[168:171], v[44:47], a[72:79], v80
  ds_read_b128 a[36:39], v18 offset:28960
  v_smfmac_f32_16x16x64_bf16 v[172:175], v[60:63], a[80:87], v80
  ds_read_b128 a[40:43], v17 offset:29248
  v_smfmac_f32_16x16x64_bf16 v[176:179], v[76:79], a[88:95], v80
  ds_read_b128 a[44:47], v18 offset:29248
  v_add_u32 v83, 8, v31
  buffer_load_dword v247, v83, s[48:51], 0 offen sc1
  v_mov_b64 v[204:205], 0
  v_mov_b64 v[206:207], 0
  v_mov_b64 v[208:209], 0
  v_mov_b64 v[210:211], 0
  v_mov_b64 v[212:213], 0
  v_mov_b64 v[214:215], 0
  s_waitcnt lgkmcnt(12)
  v_pk_add_f32 v[224:225], v[224:225], v[228:229]
  v_pk_add_f32 v[232:233], v[232:233], v[236:237]
  v_pk_add_f32 v[226:227], v[226:227], v[230:231]
  v_pk_add_f32 v[234:235], v[234:235], v[238:239]
  v_pk_add_f32 v[224:225], v[224:225], v[232:233]
  v_pk_add_f32 v[226:227], v[226:227], v[234:235]
  v_pk_mul_f32 v[224:225], v[224:225], s[4:5]
  v_pk_mul_f32 v[226:227], v[226:227], s[4:5]
  v_pk_fma_f32 v[226:227], v[224:225], v[224:225], v[226:227] neg_lo:[1,0,0] neg_hi:[1,0,0]
  v_max_f32 v226, 0, v226
  v_max_f32 v227, 0, v227
  v_pk_add_f32 v[226:227], v[226:227], s[6:7]
  v_rsq_f32 v226, v226
  v_rsq_f32 v227, v227
  s_nop 0
  v_pk_mul_f32 v[226:227], v[226:227], s[8:9]
  v_pk_mul_f32 v[224:225], v[224:225], v[226:227] neg_lo:[1,0] neg_hi:[1,0]
  v_pk_fma_f32 v[132:133], v[132:133], v[226:227], v[224:225] op_sel:[0,0,0] op_sel_hi:[1,0,0]
  v_pk_fma_f32 v[134:135], v[134:135], v[226:227], v[224:225] op_sel:[0,0,0] op_sel_hi:[1,0,0]
  v_cvt_pk_bf16_f32 v132, v132, v133
  v_cvt_pk_bf16_f32 v133, v134, v135
  v_pk_fma_f32 v[136:137], v[136:137], v[226:227], v[224:225] op_sel:[0,0,0] op_sel_hi:[1,0,0]
  v_pk_fma_f32 v[138:139], v[138:139], v[226:227], v[224:225] op_sel:[0,0,0] op_sel_hi:[1,0,0]
  v_cvt_pk_bf16_f32 v136, v136, v137
  v_cvt_pk_bf16_f32 v137, v138, v139
  v_pk_fma_f32 v[140:141], v[140:141], v[226:227], v[224:225] op_sel:[0,0,0] op_sel_hi:[1,0,0]
  v_pk_fma_f32 v[142:143], v[142:143], v[226:227], v[224:225] op_sel:[0,0,0] op_sel_hi:[1,0,0]
  v_cvt_pk_bf16_f32 v140, v140, v141
  v_cvt_pk_bf16_f32 v141, v142, v143
  v_pk_fma_f32 v[144:145], v[144:145], v[226:227], v[224:225] op_sel:[0,1,1] op_sel_hi:[1,1,1]
  v_pk_fma_f32 v[146:147], v[146:147], v[226:227], v[224:225] op_sel:[0,1,1] op_sel_hi:[1,1,1]
  v_cvt_pk_bf16_f32 v144, v144, v145
  v_cvt_pk_bf16_f32 v145, v146, v147
  v_pk_fma_f32 v[148:149], v[148:149], v[226:227], v[224:225] op_sel:[0,1,1] op_sel_hi:[1,1,1]
  v_pk_fma_f32 v[150:151], v[150:151], v[226:227], v[224:225] op_sel:[0,1,1] op_sel_hi:[1,1,1]
  v_cvt_pk_bf16_f32 v148, v148, v149
  v_cvt_pk_bf16_f32 v149, v150, v151
  v_pk_fma_f32 v[152:153], v[152:153], v[226:227], v[224:225] op_sel:[0,1,1] op_sel_hi:[1,1,1]
  v_pk_fma_f32 v[154:155], v[154:155], v[226:227], v[224:225] op_sel:[0,1,1] op_sel_hi:[1,1,1]
  v_cvt_pk_bf16_f32 v152, v152, v153
  v_cvt_pk_bf16_f32 v153, v154, v155
  v_pk_add_f32 v[216:217], v[168:169], v[170:171]
  v_pk_mul_f32 v[218:219], v[168:169], v[168:169]
  v_pk_fma_f32 v[218:219], v[170:171], v[170:171], v[218:219]
  v_pk_add_f32 v[216:217], v[216:217], v[172:173]
  v_pk_fma_f32 v[218:219], v[172:173], v[172:173], v[218:219]
  v_pk_add_f32 v[216:217], v[216:217], v[174:175]
  v_pk_fma_f32 v[218:219], v[174:175], v[174:175], v[218:219]
  v_pk_add_f32 v[216:217], v[216:217], v[176:177]
  v_pk_fma_f32 v[218:219], v[176:177], v[176:177], v[218:219]
  v_pk_add_f32 v[216:217], v[216:217], v[178:179]
  v_pk_fma_f32 v[218:219], v[178:179], v[178:179], v[218:219]
  v_add_f32 v216, v216, v217
  v_add_f32 v218, v218, v219
  s_nop 1
  v_permlane16_swap_b32 v216, v218
  v_add_f32 v216, v216, v218
  ds_write_b32 v19, v216 offset:2052
  v_mov_b32 v220, 5
  s_mov_b64 exec, 1
  ds_write_b32 v81, v220
  s_mov_b64 exec, -1
  s_mov_b64 exec, s[72:73]
  ds_write_b64 v21, v[132:133] offset:0
  ds_write_b64 v21, v[136:137] offset:16
  ds_write_b64 v21, v[140:141] offset:32
  ds_write_b64 v21, v[144:145] offset:5824
  ds_write_b64 v21, v[148:149] offset:5840
  ds_write_b64 v21, v[152:153] offset:5856
  s_mov_b64 exec, -1
  s_waitcnt vmcnt(5)
  s_waitcnt lgkmcnt(15)
  v_smfmac_f32_16x16x64_bf16 v[204:207], v[32:35], a[0:7], v80
  ds_read_b128 a[48:51], v16 offset:50176
  v_smfmac_f32_16x16x64_bf16 v[192:195], v[36:39], a[0:7], v80
  ds_read_b128 a[52:55], v16 offset:53760
  v_smfmac_f32_16x16x64_bf16 v[180:183], v[40:43], a[0:7], v80
  ds_read_b128 a[56:59], v16 offset:50464
  v_smfmac_f32_16x16x64_bf16 v[208:211], v[48:51], a[8:15], v80
  ds_read_b128 a[60:63], v16 offset:54048
  v_smfmac_f32_16x16x64_bf16 v[196:199], v[52:55], a[8:15], v80
  ds_read_b128 a[64:67], v16 offset:50752
  v_smfmac_f32_16x16x64_bf16 v[184:187], v[56:59], a[8:15], v80
  ds_read_b128 a[68:71], v16 offset:54336
  s_waitcnt lgkmcnt(15)
  v_smfmac_f32_16x16x64_bf16 v[212:215], v[64:67], a[16:23], v80
  ds_read_b128 a[72:75], v17 offset:35840
  v_smfmac_f32_16x16x64_bf16 v[200:203], v[68:71], a[16:23], v80
  ds_read_b128 a[76:79], v18 offset:35840
  v_smfmac_f32_16x16x64_bf16 v[188:191], v[72:75], a[16:23], v80
  ds_read_b128 a[80:83], v17 offset:36128
  v_smfmac_f32_16x16x64_bf16 v[180:183], v[44:47], a[24:31], v80
  ds_read_b128 a[84:87], v18 offset:36128
  v_smfmac_f32_16x16x64_bf16 v[184:187], v[60:63], a[32:39], v80
  ds_read_b128 a[88:91], v17 offset:36416
  s_waitcnt lgkmcnt(15)
  v_smfmac_f32_16x16x64_bf16 v[188:191], v[76:79], a[40:47], v80
  ds_read_b128 a[92:95], v18 offset:36416
  s_waitcnt vmcnt(0)
  v_cmp_gt_u32 vcc, 36, v247
  s_cbranch_vccz L_pck_ok
  s_mov_b32 s78, 400000
L_pck:
  s_sleep 6
  buffer_load_dword v247, v83, s[48:51], 0 offen sc1
  s_waitcnt vmcnt(0)
  v_cmp_gt_u32 vcc, 36, v247
  s_cbranch_vccz L_pck_ok
  s_sub_u32 s78, s78, 1
  s_cmp_lg_u32 s78, 0
  s_cbranch_scc1 L_pck
L_pck_ok:
  s_mul_i32 s101, s22, 18432
  s_add_u32 s101, s101, 786432
  buffer_load_dwordx4 a[144:147], v23, s[44:47], s101 offen offset:0 sc1
  buffer_load_dwordx4 a[148:151], v23, s[44:47], s101 offen offset:1024 sc1
  buffer_load_dwordx4 a[152:155], v23, s[44:47], s101 offen offset:2048 sc1
  v_pk_add_f32 v[216:217], v[180:181], v[182:183]
  v_pk_mul_f32 v[218:219], v[180:181], v[180:181]
  v_pk_fma_f32 v[218:219], v[182:183], v[182:183], v[218:219]
  v_pk_add_f32 v[216:217], v[216:217], v[184:185]
  v_pk_fma_f32 v[218:219], v[184:185], v[184:185], v[218:219]
  v_pk_add_f32 v[216:217], v[216:217], v[186:187]
  v_pk_fma_f32 v[218:219], v[186:187], v[186:187], v[218:219]
  v_pk_add_f32 v[216:217], v[216:217], v[188:189]
  v_pk_fma_f32 v[218:219], v[188:189], v[188:189], v[218:219]
  v_pk_add_f32 v[216:217], v[216:217], v[190:191]
  v_pk_fma_f32 v[218:219], v[190:191], v[190:191], v[218:219]
  v_add_f32 v216, v216, v217
  v_add_f32 v218, v218, v219
  s_nop 1
  v_permlane16_swap_b32 v216, v218
  v_add_f32 v216, v216, v218
  ds_read_b128 v[224:227], v82
  buffer_load_dwordx4 a[156:159], v23, s[44:47], s101 offen offset:3072 sc1
  s_add_u32 s101, s101, 4096
  buffer_load_dwordx4 a[160:163], v23, s[44:47], s101 offen offset:0 sc1
  buffer_load_dwordx4 a[164:167], v23, s[44:47], s101 offen offset:1024 sc1
  ds_write_b32 v19, v216 offset:4096
  buffer_load_dwordx4 a[168:171], v23, s[44:47], s101 offen offset:2048 sc1
  buffer_load_dwordx4 a[172:175], v23, s[44:47], s101 offen offset:3072 sc1
  s_add_u32 s101, s101, 4096
  buffer_load_dwordx4 a[176:179], v23, s[44:47], s101 offen offset:0 sc1
  s_waitcnt lgkmcnt(1)
  v_min_u32 v224, v224, v225
  v_min3_u32 v224, v224, v226, v227
  v_cmp_gt_u32 vcc, 5, v224
  s_cbranch_vccz L_cf5_ok
L_cf5:
  ds_read_b128 v[224:227], v82
  s_waitcnt lgkmcnt(0)
  v_min_u32 v224, v224, v225
  v_min3_u32 v224, v224, v226, v227
  v_cmp_gt_u32 vcc, 5, v224
  s_cbranch_vccnz L_cf5
L_cf5_ok:
  ds_read_b128 v[224:227], v20 offset:2048
  ds_read_b128 v[228:231], v20 offset:2064
  ds_read_b128 v[232:235], v20 offset:2080
  ds_read_b128 v[236:239], v20 offset:2096
  v_smfmac_f32_16x16x64_bf16 v[204:207], v[36:39], a[48:55], v80
  v_smfmac_f32_16x16x64_bf16 v[192:195], v[40:43], a[48:55], v80
  v_smfmac_f32_16x16x64_bf16 v[208:211], v[52:55], a[56:63], v80
  v_smfmac_f32_16x16x64_bf16 v[196:199], v[56:59], a[56:63], v80
  v_smfmac_f32_16x16x64_bf16 v[212:215], v[68:71], a[64:71], v80
  v_smfmac_f32_16x16x64_bf16 v[200:203], v[72:75], a[64:71], v80
  v_smfmac_f32_16x16x64_bf16 v[192:195], v[44:47], a[72:79], v80
  v_smfmac_f32_16x16x64_bf16 v[196:199], v[60:63], a[80:87], v80
  v_smfmac_f32_16x16x64_bf16 v[200:203], v[76:79], a[88:95], v80
  buffer_load_dwordx4 a[180:183], v23, s[44:47], s101 offen offset:1024 sc1
  buffer_load_dwordx4 a[184:187], v23, s[44:47], s101 offen offset:2048 sc1
  buffer_load_dwordx4 a[188:191], v23, s[44:47], s101 offen offset:3072 sc1
  s_waitcnt lgkmcnt(0)
  v_pk_add_f32 v[224:225], v[224:225], v[228:229]
  v_pk_add_f32 v[232:233], v[232:233], v[236:237]
  v_pk_add_f32 v[226:227], v[226:227], v[230:231]
  v_pk_add_f32 v[234:235], v[234:235], v[238:239]
  v_pk_add_f32 v[224:225], v[224:225], v[232:233]
  v_pk_add_f32 v[226:227], v[226:227], v[234:235]
  v_pk_mul_f32 v[224:225], v[224:225], s[4:5]
  v_pk_mul_f32 v[226:227], v[226:227], s[4:5]
  v_pk_fma_f32 v[226:227], v[224:225], v[224:225], v[226:227] neg_lo:[1,0,0] neg_hi:[1,0,0]
  v_max_f32 v226, 0, v226
  v_max_f32 v227, 0, v227
  v_pk_add_f32 v[226:227], v[226:227], s[6:7]
  v_rsq_f32 v226, v226
  v_rsq_f32 v227, v227
  s_nop 0
  v_pk_mul_f32 v[226:227], v[226:227], s[8:9]
  v_pk_mul_f32 v[224:225], v[224:225], v[226:227] neg_lo:[1,0] neg_hi:[1,0]
  v_pk_fma_f32 v[156:157], v[156:157], v[226:227], v[224:225] op_sel:[0,0,0] op_sel_hi:[1,0,0]
  v_pk_fma_f32 v[158:159], v[158:159], v[226:227], v[224:225] op_sel:[0,0,0] op_sel_hi:[1,0,0]
  v_cvt_pk_bf16_f32 v156, v156, v157
  v_cvt_pk_bf16_f32 v157, v158, v159
  v_pk_fma_f32 v[160:161], v[160:161], v[226:227], v[224:225] op_sel:[0,0,0] op_sel_hi:[1,0,0]
  v_pk_fma_f32 v[162:163], v[162:163], v[226:227], v[224:225] op_sel:[0,0,0] op_sel_hi:[1,0,0]
  v_cvt_pk_bf16_f32 v160, v160, v161
  v_cvt_pk_bf16_f32 v161, v162, v163
  v_pk_fma_f32 v[164:165], v[164:165], v[226:227], v[224:225] op_sel:[0,0,0] op_sel_hi:[1,0,0]
  v_pk_fma_f32 v[166:167], v[166:167], v[226:227], v[224:225] op_sel:[0,0,0] op_sel_hi:[1,0,0]
  v_cvt_pk_bf16_f32 v164, v164, v165
  v_cvt_pk_bf16_f32 v165, v166, v167
  v_pk_fma_f32 v[168:169], v[168:169], v[226:227], v[224:225] op_sel:[0,1,1] op_sel_hi:[1,1,1]
  v_pk_fma_f32 v[170:171], v[170:171], v[226:227], v[224:225] op_sel:[0,1,1] op_sel_hi:[1,1,1]
  v_cvt_pk_bf16_f32 v168, v168, v169
  v_cvt_pk_bf16_f32 v169, v170, v171
  v_pk_fma_f32 v[172:173], v[172:173], v[226:227], v[224:225] op_sel:[0,1,1] op_sel_hi:[1,1,1]
  v_pk_fma_f32 v[174:175], v[174:175], v[226:227], v[224:225] op_sel:[0,1,1] op_sel_hi:[1,1,1]
  v_cvt_pk_bf16_f32 v172, v172, v173
  v_cvt_pk_bf16_f32 v173, v174, v175
  v_pk_fma_f32 v[176:177], v[176:177], v[226:227], v[224:225] op_sel:[0,1,1] op_sel_hi:[1,1,1]
  v_pk_fma_f32 v[178:179], v[178:179], v[226:227], v[224:225] op_sel:[0,1,1] op_sel_hi:[1,1,1]
  v_cvt_pk_bf16_f32 v176, v176, v177
  v_cvt_pk_bf16_f32 v177, v178, v179
  v_pk_add_f32 v[216:217], v[192:193], v[194:195]
  v_pk_mul_f32 v[218:219], v[192:193], v[192:193]
  v_pk_fma_f32 v[218:219], v[194:195], v[194:195], v[218:219]
  v_pk_add_f32 v[216:217], v[216:217], v[196:197]
  v_pk_fma_f32 v[218:219], v[196:197], v[196:197], v[218:219]
  v_pk_add_f32 v[216:217], v[216:217], v[198:199]
  v_pk_fma_f32 v[218:219], v[198:199], v[198:199], v[218:219]
  v_pk_add_f32 v[216:217], v[216:217], v[200:201]
  v_pk_fma_f32 v[218:219], v[200:201], v[200:201], v[218:219]
  v_pk_add_f32 v[216:217], v[216:217], v[202:203]
  v_pk_fma_f32 v[218:219], v[202:203], v[202:203], v[218:219]
  v_add_f32 v216, v216, v217
  v_add_f32 v218, v218, v219
  s_nop 1
  v_permlane16_swap_b32 v216, v218
  v_add_f32 v216, v216, v218
  s_add_u32 s101, s101, 4096
  buffer_load_dwordx4 a[192:195], v23, s[44:47], s101 offen offset:0 sc1
  buffer_load_dwordx4 a[196:199], v23, s[44:47], s101 offen offset:1024 sc1
  buffer_load_dwordx4 a[200:203], v23, s[44:47], s101 offen offset:2048 sc1
  ds_write_b32 v19, v216 offset:4100
  v_mov_b32 v220, 7
  s_mov_b64 exec, 1
  ds_write_b32 v81, v220
  s_mov_b64 exec, -1
  s_mov_b64 exec, s[72:73]
  ds_write_b64 v21, v[156:157] offset:11648
  ds_write_b64 v21, v[160:161] offset:11664
  ds_write_b64 v21, v[164:165] offset:11680
  ds_write_b64 v21, v[168:169] offset:17472
  ds_write_b64 v21, v[172:173] offset:17488
  ds_write_b64 v21, v[176:177] offset:17504
  s_mov_b64 exec, -1
  buffer_load_dwordx4 a[204:207], v23, s[44:47], s101 offen offset:3072 sc1
  s_add_u32 s101, s101, 4096
  buffer_load_dwordx4 a[208:211], v23, s[44:47], s101 offen offset:0 sc1
  buffer_load_dwordx4 a[212:215], v23, s[44:47], s101 offen offset:1024 sc1
  ds_read_b128 a[0:3], v16 offset:57344
  ds_read_b128 a[4:7], v16 offset:60928
  ds_read_b128 a[8:11], v16 offset:57632
  ds_read_b128 a[12:15], v16 offset:61216
  ds_read_b128 a[16:19], v16 offset:57920
  ds_read_b128 a[20:23], v16 offset:61504
  ds_read_b128 a[24:27], v17 offset:43008
  ds_read_b128 a[28:31], v18 offset:43008
  ds_read_b128 a[32:35], v17 offset:43296
  ds_read_b128 a[36:39], v18 offset:43296
  ds_read_b128 a[40:43], v17 offset:43584
  ds_read_b128 a[44:47], v18 offset:43584
  s_waitcnt lgkmcnt(10)
  v_smfmac_f32_16x16x64_bf16 v[204:207], v[40:43], a[0:7], v80
  s_waitcnt lgkmcnt(8)
  v_smfmac_f32_16x16x64_bf16 v[208:211], v[56:59], a[8:15], v80
  s_waitcnt lgkmcnt(6)
  v_smfmac_f32_16x16x64_bf16 v[212:215], v[72:75], a[16:23], v80
  s_waitcnt lgkmcnt(4)
  v_smfmac_f32_16x16x64_bf16 v[204:207], v[44:47], a[24:31], v80
  s_waitcnt lgkmcnt(2)
  v_smfmac_f32_16x16x64_bf16 v[208:211], v[60:63], a[32:39], v80
  s_waitcnt lgkmcnt(0)
  v_smfmac_f32_16x16x64_bf16 v[212:215], v[76:79], a[40:47], v80
  ds_read_b128 v[224:227], v82
  s_waitcnt lgkmcnt(0)
  v_min_u32 v224, v224, v225
  v_min3_u32 v224, v224, v226, v227
  v_cmp_gt_u32 vcc, 7, v224
  s_cbranch_vccz L_cf7_ok
L_cf7:
  ds_read_b128 v[224:227], v82
  s_waitcnt lgkmcnt(0)
  v_min_u32 v224, v224, v225
  v_min3_u32 v224, v224, v226, v227
  v_cmp_gt_u32 vcc, 7, v224
  s_cbranch_vccnz L_cf7
L_cf7_ok:
  ds_read_b128 v[224:227], v20 offset:4096
  ds_read_b128 v[228:231], v20 offset:4112
  ds_read_b128 v[232:235], v20 offset:4128
  ds_read_b128 v[236:239], v20 offset:4144
  ds_read_b128 v[32:35], v2 offset:0
  ds_read_b128 v[36:39], v2 offset:32
  ds_read_b128 v[40:43], v2 offset:64
  ds_read_b128 v[44:47], v2 offset:96
  ds_read_b128 v[48:51], v2 offset:128
  ds_read_b128 v[52:55], v2 offset:160
  v_pk_add_f32 v[216:217], v[204:205], v[206:207]
  v_pk_mul_f32 v[218:219], v[204:205], v[204:205]
  v_pk_fma_f32 v[218:219], v[206:207], v[206:207], v[218:219]
  v_pk_add_f32 v[216:217], v[216:217], v[208:209]
  v_pk_fma_f32 v[218:219], v[208:209], v[208:209], v[218:219]
  v_pk_add_f32 v[216:217], v[216:217], v[210:211]
  v_pk_fma_f32 v[218:219], v[210:211], v[210:211], v[218:219]
  v_pk_add_f32 v[216:217], v[216:217], v[212:213]
  v_pk_fma_f32 v[218:219], v[212:213], v[212:213], v[218:219]
  v_pk_add_f32 v[216:217], v[216:217], v[214:215]
  v_pk_fma_f32 v[218:219], v[214:215], v[214:215], v[218:219]
  v_add_f32 v216, v216, v217
  v_add_f32 v218, v218, v219
  s_nop 1
  v_permlane16_swap_b32 v216, v218
  v_add_f32 v216, v216, v218
  ds_write_b32 v19, v216 offset:6144
  v_mov_b32 v220, 8
  s_mov_b64 exec, 1
  ds_write_b32 v81, v220
  s_mov_b64 exec, -1
  s_waitcnt lgkmcnt(8)
  v_pk_add_f32 v[224:225], v[224:225], v[228:229]
  v_pk_add_f32 v[232:233], v[232:233], v[236:237]
  v_pk_add_f32 v[226:227], v[226:227], v[230:231]
  v_pk_add_f32 v[234:235], v[234:235], v[238:239]
  v_pk_add_f32 v[224:225], v[224:225], v[232:233]
  v_pk_add_f32 v[226:227], v[226:227], v[234:235]
  v_pk_mul_f32 v[224:225], v[224:225], s[4:5]
  v_pk_mul_f32 v[226:227], v[226:227], s[4:5]
  v_pk_fma_f32 v[226:227], v[224:225], v[224:225], v[226:227] neg_lo:[1,0,0] neg_hi:[1,0,0]
  v_max_f32 v226, 0, v226
  v_max_f32 v227, 0, v227
  v_pk_add_f32 v[226:227], v[226:227], s[6:7]
  v_rsq_f32 v226, v226
  v_rsq_f32 v227, v227
  s_nop 0
  v_pk_mul_f32 v[226:227], v[226:227], s[8:9]
  v_pk_mul_f32 v[224:225], v[224:225], v[226:227] neg_lo:[1,0] neg_hi:[1,0]
  v_pk_fma_f32 v[180:181], v[180:181], v[226:227], v[224:225] op_sel:[0,0,0] op_sel_hi:[1,0,0]
  v_pk_fma_f32 v[182:183], v[182:183], v[226:227], v[224:225] op_sel:[0,0,0] op_sel_hi:[1,0,0]
  v_cvt_pk_bf16_f32 v180, v180, v181
  v_cvt_pk_bf16_f32 v181, v182, v183
  v_pk_fma_f32 v[184:185], v[184:185], v[226:227], v[224:225] op_sel:[0,0,0] op_sel_hi:[1,0,0]
  v_pk_fma_f32 v[186:187], v[186:187], v[226:227], v[224:225] op_sel:[0,0,0] op_sel_hi:[1,0,0]
  v_cvt_pk_bf16_f32 v184, v184, v185
  v_cvt_pk_bf16_f32 v185, v186, v187
  v_pk_fma_f32 v[188:189], v[188:189], v[226:227], v[224:225] op_sel:[0,0,0] op_sel_hi:[1,0,0]
  v_pk_fma_f32 v[190:191], v[190:191], v[226:227], v[224:225] op_sel:[0,0,0] op_sel_hi:[1,0,0]
  v_cvt_pk_bf16_f32 v188, v188, v189
  v_cvt_pk_bf16_f32 v189, v190, v191
  v_pk_fma_f32 v[192:193], v[192:193], v[226:227], v[224:225] op_sel:[0,1,1] op_sel_hi:[1,1,1]
  v_pk_fma_f32 v[194:195], v[194:195], v[226:227], v[224:225] op_sel:[0,1,1] op_sel_hi:[1,1,1]
  v_cvt_pk_bf16_f32 v192, v192, v193
  v_cvt_pk_bf16_f32 v193, v194, v195
  v_pk_fma_f32 v[196:197], v[196:197], v[226:227], v[224:225] op_sel:[0,1,1] op_sel_hi:[1,1,1]
  v_pk_fma_f32 v[198:199], v[198:199], v[226:227], v[224:225] op_sel:[0,1,1] op_sel_hi:[1,1,1]
  v_cvt_pk_bf16_f32 v196, v196, v197
  v_cvt_pk_bf16_f32 v197, v198, v199
  v_pk_fma_f32 v[200:201], v[200:201], v[226:227], v[224:225] op_sel:[0,1,1] op_sel_hi:[1,1,1]
  v_pk_fma_f32 v[202:203], v[202:203], v[226:227], v[224:225] op_sel:[0,1,1] op_sel_hi:[1,1,1]
  v_cvt_pk_bf16_f32 v200, v200, v201
  v_cvt_pk_bf16_f32 v201, v202, v203
  ds_read_b128 v[220:223], v82
  s_waitcnt lgkmcnt(3)
  s_waitcnt vmcnt(12)
  v_mfma_f32_32x32x16_bf16 v[104:119], v[32:35], a[144:147], 0
  v_mfma_f32_32x32x16_bf16 v[104:119], v[36:39], a[148:151], v[104:119]
  v_mfma_f32_32x32x16_bf16 v[104:119], v[40:43], a[152:155], v[104:119]
  v_mfma_f32_32x32x16_bf16 v[104:119], v[44:47], a[156:159], v[104:119]
  v_mfma_f32_32x32x16_bf16 v[104:119], v[48:51], a[160:163], v[104:119]
  v_mfma_f32_32x32x16_bf16 v[104:119], v[52:55], a[164:167], v[104:119]
  s_mov_b64 exec, s[72:73]
  ds_write_b64 v21, v[180:181] offset:23296
  ds_write_b64 v21, v[184:185] offset:23312
  ds_write_b64 v21, v[188:189] offset:23328
  ds_write_b64 v21, v[192:193] offset:29120
  ds_write_b64 v21, v[196:197] offset:29136
  ds_write_b64 v21, v[200:201] offset:29152
  s_mov_b64 exec, -1
  s_waitcnt lgkmcnt(6)
  v_min_u32 v220, v220, v221
  v_min3_u32 v220, v220, v222, v223
  v_cmp_gt_u32 vcc, 8, v220
  s_cbranch_vccz L_cf8_ok
L_cf8:
  ds_read_b128 v[220:223], v82
  s_waitcnt lgkmcnt(0)
  v_min_u32 v220, v220, v221
  v_min3_u32 v220, v220, v222, v223
  v_cmp_gt_u32 vcc, 8, v220
  s_cbranch_vccnz L_cf8
L_cf8_ok:
  ds_read_b128 v[120:123], v20 offset:6144
  ds_read_b128 v[124:127], v20 offset:6160
  ds_read_b128 v[128:131], v20 offset:6176
  ds_read_b128 v[132:135], v20 offset:6192
  v_mov_b64 v[160:161], 0
  v_mov_b64 v[162:163], 0
  v_mov_b64 v[164:165], 0
  v_mov_b64 v[166:167], 0
  v_mov_b64 v[168:169], 0
  v_mov_b64 v[170:171], 0
  v_mov_b32 v17, 163600
  s_lshl_b32 s62, s22, 2
  v_add_u32 v29, s62, v17
  s_waitcnt lgkmcnt(0)
  v_pk_add_f32 v[120:121], v[120:121], v[124:125]
  v_pk_add_f32 v[128:129], v[128:129], v[132:133]
  v_pk_add_f32 v[122:123], v[122:123], v[126:127]
  v_pk_add_f32 v[130:131], v[130:131], v[134:135]
  v_pk_add_f32 v[120:121], v[120:121], v[128:129]
  v_pk_add_f32 v[122:123], v[122:123], v[130:131]
  v_pk_mul_f32 v[120:121], v[120:121], s[4:5]
  v_pk_mul_f32 v[122:123], v[122:123], s[4:5]
  v_pk_fma_f32 v[122:123], v[120:121], v[120:121], v[122:123] neg_lo:[1,0,0] neg_hi:[1,0,0]
  v_max_f32 v122, 0, v122
  v_max_f32 v123, 0, v123
  v_pk_add_f32 v[122:123], v[122:123], s[6:7]
  v_rsq_f32 v122, v122
  v_rsq_f32 v123, v123
  s_nop 0
  v_pk_mul_f32 v[122:123], v[122:123], s[8:9]
  v_pk_mul_f32 v[120:121], v[120:121], v[122:123] neg_lo:[1,0] neg_hi:[1,0]
  v_pk_fma_f32 v[204:205], v[204:205], v[122:123], v[120:121] op_sel:[0,0,0] op_sel_hi:[1,0,0]
  v_pk_fma_f32 v[206:207], v[206:207], v[122:123], v[120:121] op_sel:[0,0,0] op_sel_hi:[1,0,0]
  v_cvt_pk_bf16_f32 v204, v204, v205
  v_cvt_pk_bf16_f32 v205, v206, v207
  v_pk_fma_f32 v[208:209], v[208:209], v[122:123], v[120:121] op_sel:[0,0,0] op_sel_hi:[1,0,0]
  v_pk_fma_f32 v[210:211], v[210:211], v[122:123], v[120:121] op_sel:[0,0,0] op_sel_hi:[1,0,0]
  v_cvt_pk_bf16_f32 v208, v208, v209
  v_cvt_pk_bf16_f32 v209, v210, v211
  v_pk_fma_f32 v[212:213], v[212:213], v[122:123], v[120:121] op_sel:[0,0,0] op_sel_hi:[1,0,0]
  v_pk_fma_f32 v[214:215], v[214:215], v[122:123], v[120:121] op_sel:[0,0,0] op_sel_hi:[1,0,0]
  v_cvt_pk_bf16_f32 v212, v212, v213
  v_cvt_pk_bf16_f32 v213, v214, v215
  s_mov_b64 exec, s[72:73]
  ds_write_b64 v21, v[204:205] offset:34944
  ds_write_b64 v21, v[208:209] offset:34960
  ds_write_b64 v21, v[212:213] offset:34976
  s_mov_b64 exec, -1
  s_waitcnt vmcnt(0)
  v_pk_fma_f32 v[136:137], v[104:105], v[104:105], s[74:75]
  v_pk_fma_f32 v[138:139], v[106:107], v[106:107], s[74:75]
  v_pk_fma_f32 v[140:141], v[108:109], v[108:109], s[74:75]
  v_pk_fma_f32 v[142:143], v[110:111], v[110:111], s[74:75]
  v_pk_fma_f32 v[144:145], v[112:113], v[112:113], s[74:75]
  v_pk_fma_f32 v[146:147], v[114:115], v[114:115], s[74:75]
  v_pk_fma_f32 v[148:149], v[116:117], v[116:117], s[74:75]
  v_pk_fma_f32 v[150:151], v[118:119], v[118:119], s[74:75]
  v_pk_mul_f32 v[136:137], v[104:105], v[136:137]
  v_pk_mul_f32 v[138:139], v[106:107], v[138:139]
  v_pk_mul_f32 v[140:141], v[108:109], v[140:141]
  v_pk_mul_f32 v[142:143], v[110:111], v[142:143]
  v_pk_mul_f32 v[144:145], v[112:113], v[144:145]
  v_pk_mul_f32 v[146:147], v[114:115], v[146:147]
  v_pk_mul_f32 v[148:149], v[116:117], v[148:149]
  v_pk_mul_f32 v[150:151], v[118:119], v[150:151]
  v_mfma_f32_32x32x16_bf16 v[120:135], v[32:35], a[168:171], 0
  v_exp_f32 v136, v136
  v_exp_f32 v137, v137
  v_exp_f32 v138, v138
  v_exp_f32 v139, v139
  v_exp_f32 v140, v140
  v_mfma_f32_32x32x16_bf16 v[120:135], v[36:39], a[172:175], v[120:135]
  v_exp_f32 v141, v141
  v_exp_f32 v142, v142
  v_exp_f32 v143, v143
  v_exp_f32 v144, v144
  v_exp_f32 v145, v145
  v_mfma_f32_32x32x16_bf16 v[120:135], v[40:43], a[176:179], v[120:135]
  v_exp_f32 v146, v146
  v_exp_f32 v147, v147
  v_exp_f32 v148, v148
  v_exp_f32 v149, v149
  v_exp_f32 v150, v150
  v_exp_f32 v151, v151
  v_pk_add_f32 v[136:137], v[136:137], 1.0 op_sel_hi:[1,0]
  v_pk_add_f32 v[138:139], v[138:139], 1.0 op_sel_hi:[1,0]
  v_pk_add_f32 v[140:141], v[140:141], 1.0 op_sel_hi:[1,0]
  v_pk_add_f32 v[142:143], v[142:143], 1.0 op_sel_hi:[1,0]
  v_pk_add_f32 v[144:145], v[144:145], 1.0 op_sel_hi:[1,0]
  v_pk_add_f32 v[146:147], v[146:147], 1.0 op_sel_hi:[1,0]
  v_pk_add_f32 v[148:149], v[148:149], 1.0 op_sel_hi:[1,0]
  v_pk_add_f32 v[150:151], v[150:151], 1.0 op_sel_hi:[1,0]
  v_mfma_f32_32x32x16_bf16 v[120:135], v[44:47], a[180:183], v[120:135]
  v_rcp_f32 v136, v136
  v_rcp_f32 v137, v137
  v_rcp_f32 v138, v138
  v_rcp_f32 v139, v139
  v_rcp_f32 v140, v140
  v_mfma_f32_32x32x16_bf16 v[120:135], v[48:51], a[184:187], v[120:135]
  v_rcp_f32 v141, v141
  v_rcp_f32 v142, v142
  v_rcp_f32 v143, v143
  v_rcp_f32 v144, v144
  v_rcp_f32 v145, v145
  v_mfma_f32_32x32x16_bf16 v[120:135], v[52:55], a[188:191], v[120:135]
  v_rcp_f32 v146, v146
  v_rcp_f32 v147, v147
  v_rcp_f32 v148, v148
  v_rcp_f32 v149, v149
  v_rcp_f32 v150, v150
  v_rcp_f32 v151, v151
  v_pk_mul_f32 v[136:137], v[104:105], v[136:137]
  v_pk_mul_f32 v[138:139], v[106:107], v[138:139]
  v_pk_mul_f32 v[140:141], v[108:109], v[140:141]
  v_pk_mul_f32 v[142:143], v[110:111], v[142:143]
  v_pk_mul_f32 v[144:145], v[112:113], v[144:145]
  v_pk_mul_f32 v[146:147], v[114:115], v[146:147]
  v_pk_mul_f32 v[148:149], v[116:117], v[148:149]
  v_pk_mul_f32 v[150:151], v[118:119], v[150:151]
  v_pk_fma_f32 v[160:161], v[136:137], v[136:137], v[160:161]
  v_pk_fma_f32 v[162:163], v[138:139], v[138:139], v[162:163]
  v_pk_fma_f32 v[160:161], v[140:141], v[140:141], v[160:161]
  v_pk_fma_f32 v[162:163], v[142:143], v[142:143], v[162:163]
  v_pk_fma_f32 v[160:161], v[144:145], v[144:145], v[160:161]
  v_pk_fma_f32 v[162:163], v[146:147], v[146:147], v[162:163]
  v_pk_fma_f32 v[160:161], v[148:149], v[148:149], v[160:161]
  v_pk_fma_f32 v[162:163], v[150:151], v[150:151], v[162:163]
  v_cvt_pk_bf16_f32 v152, v136, v137
  v_cvt_pk_bf16_f32 v153, v138, v139
  v_cvt_pk_bf16_f32 v154, v140, v141
  v_cvt_pk_bf16_f32 v155, v142, v143
  v_cvt_pk_bf16_f32 v156, v144, v145
  v_cvt_pk_bf16_f32 v157, v146, v147
  v_cvt_pk_bf16_f32 v158, v148, v149
  v_cvt_pk_bf16_f32 v159, v150, v151
  ds_read_b128 v[56:59], v2 offset:6656
  ds_read_b128 v[60:63], v2 offset:6688
  ds_read_b128 v[64:67], v2 offset:6720
  ds_read_b128 v[68:71], v2 offset:6752
  ds_read_b128 v[72:75], v2 offset:6784
  ds_read_b128 v[76:79], v2 offset:6816
  ds_write_b128 v4, v[152:155] offset:0
  ds_write_b128 v5, v[156:159] offset:0
  buffer_load_dwordx4 v[172:175], v23, s[44:47], s11 offen offset:0 sc1
  buffer_load_dwordx4 v[176:179], v23, s[44:47], s11 offen offset:1024 sc1
  v_pk_fma_f32 v[136:137], v[120:121], v[120:121], s[74:75]
  v_pk_fma_f32 v[138:139], v[122:123], v[122:123], s[74:75]
  v_pk_fma_f32 v[140:141], v[124:125], v[124:125], s[74:75]
  v_pk_fma_f32 v[142:143], v[126:127], v[126:127], s[74:75]
  v_pk_fma_f32 v[144:145], v[128:129], v[128:129], s[74:75]
  v_pk_fma_f32 v[146:147], v[130:131], v[130:131], s[74:75]
  v_pk_fma_f32 v[148:149], v[132:133], v[132:133], s[74:75]
  v_pk_fma_f32 v[150:151], v[134:135], v[134:135], s[74:75]
  v_pk_mul_f32 v[136:137], v[120:121], v[136:137]
  v_pk_mul_f32 v[138:139], v[122:123], v[138:139]
  v_pk_mul_f32 v[140:141], v[124:125], v[140:141]
  v_pk_mul_f32 v[142:143], v[126:127], v[142:143]
  v_pk_mul_f32 v[144:145], v[128:129], v[144:145]
  v_pk_mul_f32 v[146:147], v[130:131], v[146:147]
  v_pk_mul_f32 v[148:149], v[132:133], v[148:149]
  v_pk_mul_f32 v[150:151], v[134:135], v[150:151]
  v_mfma_f32_32x32x16_bf16 v[104:119], v[32:35], a[192:195], 0
  v_exp_f32 v136, v136
  v_exp_f32 v137, v137
  v_exp_f32 v138, v138
  v_exp_f32 v139, v139
  v_exp_f32 v140, v140
  v_mfma_f32_32x32x16_bf16 v[104:119], v[36:39], a[196:199], v[104:119]
  v_exp_f32 v141, v141
  v_exp_f32 v142, v142
  v_exp_f32 v143, v143
  v_exp_f32 v144, v144
  v_exp_f32 v145, v145
  v_mfma_f32_32x32x16_bf16 v[104:119], v[40:43], a[200:203], v[104:119]
  v_exp_f32 v146, v146
  v_exp_f32 v147, v147
  v_exp_f32 v148, v148
  v_exp_f32 v149, v149
  v_exp_f32 v150, v150
  v_exp_f32 v151, v151
  v_pk_add_f32 v[136:137], v[136:137], 1.0 op_sel_hi:[1,0]
  v_pk_add_f32 v[138:139], v[138:139], 1.0 op_sel_hi:[1,0]
  v_pk_add_f32 v[140:141], v[140:141], 1.0 op_sel_hi:[1,0]
  v_pk_add_f32 v[142:143], v[142:143], 1.0 op_sel_hi:[1,0]
  v_pk_add_f32 v[144:145], v[144:145], 1.0 op_sel_hi:[1,0]
  v_pk_add_f32 v[146:147], v[146:147], 1.0 op_sel_hi:[1,0]
  v_pk_add_f32 v[148:149], v[148:149], 1.0 op_sel_hi:[1,0]
  v_pk_add_f32 v[150:151], v[150:151], 1.0 op_sel_hi:[1,0]
  v_mfma_f32_32x32x16_bf16 v[104:119], v[44:47], a[204:207], v[104:119]
  v_rcp_f32 v136, v136
  v_rcp_f32 v137, v137
  v_rcp_f32 v138, v138
  v_rcp_f32 v139, v139
  v_rcp_f32 v140, v140
  v_mfma_f32_32x32x16_bf16 v[104:119], v[48:51], a[208:211], v[104:119]
  v_rcp_f32 v141, v141
  v_rcp_f32 v142, v142
  v_rcp_f32 v143, v143
  v_rcp_f32 v144, v144
  v_rcp_f32 v145, v145
  v_mfma_f32_32x32x16_bf16 v[104:119], v[52:55], a[212:215], v[104:119]
  v_rcp_f32 v146, v146
  v_rcp_f32 v147, v147
  v_rcp_f32 v148, v148
  v_rcp_f32 v149, v149
  v_rcp_f32 v150, v150
  v_rcp_f32 v151, v151
  v_pk_mul_f32 v[136:137], v[120:121], v[136:137]
  v_pk_mul_f32 v[138:139], v[122:123], v[138:139]
  v_pk_mul_f32 v[140:141], v[124:125], v[140:141]
  v_pk_mul_f32 v[142:143], v[126:127], v[142:143]
  v_pk_mul_f32 v[144:145], v[128:129], v[144:145]
  v_pk_mul_f32 v[146:147], v[130:131], v[146:147]
  v_pk_mul_f32 v[148:149], v[132:133], v[148:149]
  v_pk_mul_f32 v[150:151], v[134:135], v[150:151]
  v_pk_fma_f32 v[164:165], v[136:137], v[136:137], v[164:165]
  v_pk_fma_f32 v[166:167], v[138:139], v[138:139], v[166:167]
  v_pk_fma_f32 v[164:165], v[140:141], v[140:141], v[164:165]
  v_pk_fma_f32 v[166:167], v[142:143], v[142:143], v[166:167]
  v_pk_fma_f32 v[164:165], v[144:145], v[144:145], v[164:165]
  v_pk_fma_f32 v[166:167], v[146:147], v[146:147], v[166:167]
  v_pk_fma_f32 v[164:165], v[148:149], v[148:149], v[164:165]
  v_pk_fma_f32 v[166:167], v[150:151], v[150:151], v[166:167]
  v_cvt_pk_bf16_f32 v152, v136, v137
  v_cvt_pk_bf16_f32 v153, v138, v139
  v_cvt_pk_bf16_f32 v154, v140, v141
  v_cvt_pk_bf16_f32 v155, v142, v143
  v_cvt_pk_bf16_f32 v156, v144, v145
  v_cvt_pk_bf16_f32 v157, v146, v147
  v_cvt_pk_bf16_f32 v158, v148, v149
  v_cvt_pk_bf16_f32 v159, v150, v151
  ds_write_b128 v4, v[152:155] offset:4096
  ds_write_b128 v5, v[156:159] offset:4096
  s_cmp_lg_u32 s22, 0
  s_cbranch_scc1 L_noarrive
  s_and_b32 s62, s2, 3
  s_lshl_b32 s62, s62, 6
  v_mov_b32 v254, s62
  v_mov_b32 v255, 1
  s_mov_b64 exec, 1
  buffer_atomic_add v255, v254, s[48:51], 0 offen
  s_mov_b64 exec, -1
L_noarrive:
  buffer_load_dwordx4 v[180:183], v23, s[44:47], s11 offen offset:2048 sc1
  buffer_load_dwordx4 v[184:187], v23, s[44:47], s11 offen offset:3072 sc1
  buffer_load_dwordx2 v[250:251], v28, s[56:59], 0 offen offset:0
  buffer_load_dwordx2 v[252:253], v28, s[56:59], 0 offen offset:16
  s_waitcnt lgkmcnt(4)
  v_pk_fma_f32 v[136:137], v[104:105], v[104:105], s[74:75]
  v_pk_fma_f32 v[138:139], v[106:107], v[106:107], s[74:75]
  v_pk_fma_f32 v[140:141], v[108:109], v[108:109], s[74:75]
  v_pk_fma_f32 v[142:143], v[110:111], v[110:111], s[74:75]
  v_pk_fma_f32 v[144:145], v[112:113], v[112:113], s[74:75]
  v_pk_fma_f32 v[146:147], v[114:115], v[114:115], s[74:75]
  v_pk_fma_f32 v[148:149], v[116:117], v[116:117], s[74:75]
  v_pk_fma_f32 v[150:151], v[118:119], v[118:119], s[74:75]
  v_pk_mul_f32 v[136:137], v[104:105], v[136:137]
  v_pk_mul_f32 v[138:139], v[106:107], v[138:139]
  v_pk_mul_f32 v[140:141], v[108:109], v[140:141]
  v_pk_mul_f32 v[142:143], v[110:111], v[142:143]
  v_pk_mul_f32 v[144:145], v[112:113], v[144:145]
  v_pk_mul_f32 v[146:147], v[114:115], v[146:147]
  v_pk_mul_f32 v[148:149], v[116:117], v[148:149]
  v_pk_mul_f32 v[150:151], v[118:119], v[150:151]
  v_mfma_f32_32x32x16_bf16 v[120:135], v[56:59], a[144:147], 0
  v_exp_f32 v136, v136
  v_exp_f32 v137, v137
  v_exp_f32 v138, v138
  v_exp_f32 v139, v139
  v_exp_f32 v140, v140
  v_mfma_f32_32x32x16_bf16 v[120:135], v[60:63], a[148:151], v[120:135]
  v_exp_f32 v141, v141
  v_exp_f32 v142, v142
  v_exp_f32 v143, v143
  v_exp_f32 v144, v144
  v_exp_f32 v145, v145
  v_mfma_f32_32x32x16_bf16 v[120:135], v[64:67], a[152:155], v[120:135]
  v_exp_f32 v146, v146
  v_exp_f32 v147, v147
  v_exp_f32 v148, v148
  v_exp_f32 v149, v149
  v_exp_f32 v150, v150
  v_exp_f32 v151, v151
  v_pk_add_f32 v[136:137], v[136:137], 1.0 op_sel_hi:[1,0]
  v_pk_add_f32 v[138:139], v[138:139], 1.0 op_sel_hi:[1,0]
  v_pk_add_f32 v[140:141], v[140:141], 1.0 op_sel_hi:[1,0]
  v_pk_add_f32 v[142:143], v[142:143], 1.0 op_sel_hi:[1,0]
  v_pk_add_f32 v[144:145], v[144:145], 1.0 op_sel_hi:[1,0]
  v_pk_add_f32 v[146:147], v[146:147], 1.0 op_sel_hi:[1,0]
  v_pk_add_f32 v[148:149], v[148:149], 1.0 op_sel_hi:[1,0]
  v_pk_add_f32 v[150:151], v[150:151], 1.0 op_sel_hi:[1,0]
  v_mfma_f32_32x32x16_bf16 v[120:135], v[68:71], a[156:159], v[120:135]
  v_rcp_f32 v136, v136
  v_rcp_f32 v137, v137
  v_rcp_f32 v138, v138
  v_rcp_f32 v139, v139
  v_rcp_f32 v140, v140
  v_mfma_f32_32x32x16_bf16 v[120:135], v[72:75], a[160:163], v[120:135]
  v_rcp_f32 v141, v141
  v_rcp_f32 v142, v142
  v_rcp_f32 v143, v143
  v_rcp_f32 v144, v144
  v_rcp_f32 v145, v145
  v_mfma_f32_32x32x16_bf16 v[120:135], v[76:79], a[164:167], v[120:135]
  v_rcp_f32 v146, v146
  v_rcp_f32 v147, v147
  v_rcp_f32 v148, v148
  v_rcp_f32 v149, v149
  v_rcp_f32 v150, v150
  v_rcp_f32 v151, v151
  v_pk_mul_f32 v[136:137], v[104:105], v[136:137]
  v_pk_mul_f32 v[138:139], v[106:107], v[138:139]
  v_pk_mul_f32 v[140:141], v[108:109], v[140:141]
  v_pk_mul_f32 v[142:143], v[110:111], v[142:143]
  v_pk_mul_f32 v[144:145], v[112:113], v[144:145]
  v_pk_mul_f32 v[146:147], v[114:115], v[146:147]
  v_pk_mul_f32 v[148:149], v[116:117], v[148:149]
  v_pk_mul_f32 v[150:151], v[118:119], v[150:151]
  v_pk_fma_f32 v[168:169], v[136:137], v[136:137], v[168:169]
  v_pk_fma_f32 v[170:171], v[138:139], v[138:139], v[170:171]
  v_pk_fma_f32 v[168:169], v[140:141], v[140:141], v[168:169]
  v_pk_fma_f32 v[170:171], v[142:143], v[142:143], v[170:171]
  v_pk_fma_f32 v[168:169], v[144:145], v[144:145], v[168:169]
  v_pk_fma_f32 v[170:171], v[146:147], v[146:147], v[170:171]
  v_pk_fma_f32 v[168:169], v[148:149], v[148:149], v[168:169]
  v_pk_fma_f32 v[170:171], v[150:151], v[150:151], v[170:171]
  v_cvt_pk_bf16_f32 v152, v136, v137
  v_cvt_pk_bf16_f32 v153, v138, v139
  v_cvt_pk_bf16_f32 v154, v140, v141
  v_cvt_pk_bf16_f32 v155, v142, v143
  v_cvt_pk_bf16_f32 v156, v144, v145
  v_cvt_pk_bf16_f32 v157, v146, v147
  v_cvt_pk_bf16_f32 v158, v148, v149
  v_cvt_pk_bf16_f32 v159, v150, v151
  ds_write_b128 v4, v[152:155] offset:8192
  ds_write_b128 v5, v[156:159] offset:8192
  buffer_load_dwordx4 v[188:191], v23, s[44:47], s13 offen offset:0 sc1
  buffer_load_dwordx4 v[192:195], v23, s[44:47], s13 offen offset:1024 sc1
  s_add_u32 s11, s11, 6144
  s_add_u32 s13, s13, 6144
  v_pk_fma_f32 v[136:137], v[120:121], v[120:121], s[74:75]
  v_pk_fma_f32 v[138:139], v[122:123], v[122:123], s[74:75]
  v_pk_fma_f32 v[140:141], v[124:125], v[124:125], s[74:75]
  v_pk_fma_f32 v[142:143], v[126:127], v[126:127], s[74:75]
  v_pk_fma_f32 v[144:145], v[128:129], v[128:129], s[74:75]
  v_pk_fma_f32 v[146:147], v[130:131], v[130:131], s[74:75]
  v_pk_fma_f32 v[148:149], v[132:133], v[132:133], s[74:75]
  v_pk_fma_f32 v[150:151], v[134:135], v[134:135], s[74:75]
  v_pk_mul_f32 v[136:137], v[120:121], v[136:137]
  v_pk_mul_f32 v[138:139], v[122:123], v[138:139]
  v_pk_mul_f32 v[140:141], v[124:125], v[140:141]
  v_pk_mul_f32 v[142:143], v[126:127], v[142:143]
  v_pk_mul_f32 v[144:145], v[128:129], v[144:145]
  v_pk_mul_f32 v[146:147], v[130:131], v[146:147]
  v_pk_mul_f32 v[148:149], v[132:133], v[148:149]
  v_pk_mul_f32 v[150:151], v[134:135], v[150:151]
  v_mfma_f32_32x32x16_bf16 v[104:119], v[56:59], a[168:171], 0
  v_exp_f32 v136, v136
  v_exp_f32 v137, v137
  v_exp_f32 v138, v138
  v_exp_f32 v139, v139
  v_exp_f32 v140, v140
  v_mfma_f32_32x32x16_bf16 v[104:119], v[60:63], a[172:175], v[104:119]
  v_exp_f32 v141, v141
  v_exp_f32 v142, v142
  v_exp_f32 v143, v143
  v_exp_f32 v144, v144
  v_exp_f32 v145, v145
  v_mfma_f32_32x32x16_bf16 v[104:119], v[64:67], a[176:179], v[104:119]
  v_exp_f32 v146, v146
  v_exp_f32 v147, v147
  v_exp_f32 v148, v148
  v_exp_f32 v149, v149
  v_exp_f32 v150, v150
  v_exp_f32 v151, v151
  v_pk_add_f32 v[136:137], v[136:137], 1.0 op_sel_hi:[1,0]
  v_pk_add_f32 v[138:139], v[138:139], 1.0 op_sel_hi:[1,0]
  v_pk_add_f32 v[140:141], v[140:141], 1.0 op_sel_hi:[1,0]
  v_pk_add_f32 v[142:143], v[142:143], 1.0 op_sel_hi:[1,0]
  v_pk_add_f32 v[144:145], v[144:145], 1.0 op_sel_hi:[1,0]
  v_pk_add_f32 v[146:147], v[146:147], 1.0 op_sel_hi:[1,0]
  v_pk_add_f32 v[148:149], v[148:149], 1.0 op_sel_hi:[1,0]
  v_pk_add_f32 v[150:151], v[150:151], 1.0 op_sel_hi:[1,0]
  v_mfma_f32_32x32x16_bf16 v[104:119], v[68:71], a[180:183], v[104:119]
  v_rcp_f32 v136, v136
  v_rcp_f32 v137, v137
  v_rcp_f32 v138, v138
  v_rcp_f32 v139, v139
  v_rcp_f32 v140, v140
  v_mfma_f32_32x32x16_bf16 v[104:119], v[72:75], a[184:187], v[104:119]
  v_rcp_f32 v141, v141
  v_rcp_f32 v142, v142
  v_rcp_f32 v143, v143
  v_rcp_f32 v144, v144
  v_rcp_f32 v145, v145
  v_mfma_f32_32x32x16_bf16 v[104:119], v[76:79], a[188:191], v[104:119]
  v_rcp_f32 v146, v146
  v_rcp_f32 v147, v147
  v_rcp_f32 v148, v148
  v_rcp_f32 v149, v149
  v_rcp_f32 v150, v150
  v_rcp_f32 v151, v151
  v_pk_mul_f32 v[136:137], v[120:121], v[136:137]
  v_pk_mul_f32 v[138:139], v[122:123], v[138:139]
  v_pk_mul_f32 v[140:141], v[124:125], v[140:141]
  v_pk_mul_f32 v[142:143], v[126:127], v[142:143]
  v_pk_mul_f32 v[144:145], v[128:129], v[144:145]
  v_pk_mul_f32 v[146:147], v[130:131], v[146:147]
  v_pk_mul_f32 v[148:149], v[132:133], v[148:149]
  v_pk_mul_f32 v[150:151], v[134:135], v[150:151]
  v_pk_fma_f32 v[160:161], v[136:137], v[136:137], v[160:161]
  v_pk_fma_f32 v[162:163], v[138:139], v[138:139], v[162:163]
  v_pk_fma_f32 v[160:161], v[140:141], v[140:141], v[160:161]
  v_pk_fma_f32 v[162:163], v[142:143], v[142:143], v[162:163]
  v_pk_fma_f32 v[160:161], v[144:145], v[144:145], v[160:161]
  v_pk_fma_f32 v[162:163], v[146:147], v[146:147], v[162:163]
  v_pk_fma_f32 v[160:161], v[148:149], v[148:149], v[160:161]
  v_pk_fma_f32 v[162:163], v[150:151], v[150:151], v[162:163]
  v_cvt_pk_bf16_f32 v152, v136, v137
  v_cvt_pk_bf16_f32 v153, v138, v139
  v_cvt_pk_bf16_f32 v154, v140, v141
  v_cvt_pk_bf16_f32 v155, v142, v143
  v_cvt_pk_bf16_f32 v156, v144, v145
  v_cvt_pk_bf16_f32 v157, v146, v147
  v_cvt_pk_bf16_f32 v158, v148, v149
  v_cvt_pk_bf16_f32 v159, v150, v151
  ds_read_b128 v[32:35], v2 offset:13312
  ds_read_b128 v[36:39], v2 offset:13344
  ds_read_b128 v[40:43], v2 offset:13376
  ds_read_b128 v[44:47], v2 offset:13408
  ds_read_b128 v[48:51], v2 offset:13440
  ds_read_b128 v[52:55], v2 offset:13472
  ds_write_b128 v6, v[152:155] offset:0
  ds_write_b128 v7, v[156:159] offset:0
  v_pk_fma_f32 v[136:137], v[104:105], v[104:105], s[74:75]
  v_pk_fma_f32 v[138:139], v[106:107], v[106:107], s[74:75]
  v_pk_fma_f32 v[140:141], v[108:109], v[108:109], s[74:75]
  v_pk_fma_f32 v[142:143], v[110:111], v[110:111], s[74:75]
  v_pk_fma_f32 v[144:145], v[112:113], v[112:113], s[74:75]
  v_pk_fma_f32 v[146:147], v[114:115], v[114:115], s[74:75]
  v_pk_fma_f32 v[148:149], v[116:117], v[116:117], s[74:75]
  v_pk_fma_f32 v[150:151], v[118:119], v[118:119], s[74:75]
  v_pk_mul_f32 v[136:137], v[104:105], v[136:137]
  v_pk_mul_f32 v[138:139], v[106:107], v[138:139]
  v_pk_mul_f32 v[140:141], v[108:109], v[140:141]
  v_pk_mul_f32 v[142:143], v[110:111], v[142:143]
  v_pk_mul_f32 v[144:145], v[112:113], v[144:145]
  v_pk_mul_f32 v[146:147], v[114:115], v[146:147]
  v_pk_mul_f32 v[148:149], v[116:117], v[148:149]
  v_pk_mul_f32 v[150:151], v[118:119], v[150:151]
  v_mfma_f32_32x32x16_bf16 v[120:135], v[56:59], a[192:195], 0
  v_exp_f32 v136, v136
  v_exp_f32 v137, v137
  v_exp_f32 v138, v138
  v_exp_f32 v139, v139
  v_exp_f32 v140, v140
  v_mfma_f32_32x32x16_bf16 v[120:135], v[60:63], a[196:199], v[120:135]
  v_exp_f32 v141, v141
  v_exp_f32 v142, v142
  v_exp_f32 v143, v143
  v_exp_f32 v144, v144
  v_exp_f32 v145, v145
  v_mfma_f32_32x32x16_bf16 v[120:135], v[64:67], a[200:203], v[120:135]
  v_exp_f32 v146, v146
  v_exp_f32 v147, v147
  v_exp_f32 v148, v148
  v_exp_f32 v149, v149
  v_exp_f32 v150, v150
  v_exp_f32 v151, v151
  v_pk_add_f32 v[136:137], v[136:137], 1.0 op_sel_hi:[1,0]
  v_pk_add_f32 v[138:139], v[138:139], 1.0 op_sel_hi:[1,0]
  v_pk_add_f32 v[140:141], v[140:141], 1.0 op_sel_hi:[1,0]
  v_pk_add_f32 v[142:143], v[142:143], 1.0 op_sel_hi:[1,0]
  v_pk_add_f32 v[144:145], v[144:145], 1.0 op_sel_hi:[1,0]
  v_pk_add_f32 v[146:147], v[146:147], 1.0 op_sel_hi:[1,0]
  v_pk_add_f32 v[148:149], v[148:149], 1.0 op_sel_hi:[1,0]
  v_pk_add_f32 v[150:151], v[150:151], 1.0 op_sel_hi:[1,0]
  v_mfma_f32_32x32x16_bf16 v[120:135], v[68:71], a[204:207], v[120:135]
  v_rcp_f32 v136, v136
  v_rcp_f32 v137, v137
  v_rcp_f32 v138, v138
  v_rcp_f32 v139, v139
  v_rcp_f32 v140, v140
  v_mfma_f32_32x32x16_bf16 v[120:135], v[72:75], a[208:211], v[120:135]
  v_rcp_f32 v141, v141
  v_rcp_f32 v142, v142
  v_rcp_f32 v143, v143
  v_rcp_f32 v144, v144
  v_rcp_f32 v145, v145
  v_mfma_f32_32x32x16_bf16 v[120:135], v[76:79], a[212:215], v[120:135]
  v_rcp_f32 v146, v146
  v_rcp_f32 v147, v147
  v_rcp_f32 v148, v148
  v_rcp_f32 v149, v149
  v_rcp_f32 v150, v150
  v_rcp_f32 v151, v151
  v_pk_mul_f32 v[136:137], v[104:105], v[136:137]
  v_pk_mul_f32 v[138:139], v[106:107], v[138:139]
  v_pk_mul_f32 v[140:141], v[108:109], v[140:141]
  v_pk_mul_f32 v[142:143], v[110:111], v[142:143]
  v_pk_mul_f32 v[144:145], v[112:113], v[144:145]
  v_pk_mul_f32 v[146:147], v[114:115], v[146:147]
  v_pk_mul_f32 v[148:149], v[116:117], v[148:149]
  v_pk_mul_f32 v[150:151], v[118:119], v[150:151]
  v_pk_fma_f32 v[164:165], v[136:137], v[136:137], v[164:165]
  v_pk_fma_f32 v[166:167], v[138:139], v[138:139], v[166:167]
  v_pk_fma_f32 v[164:165], v[140:141], v[140:141], v[164:165]
  v_pk_fma_f32 v[166:167], v[142:143], v[142:143], v[166:167]
  v_pk_fma_f32 v[164:165], v[144:145], v[144:145], v[164:165]
  v_pk_fma_f32 v[166:167], v[146:147], v[146:147], v[166:167]
  v_pk_fma_f32 v[164:165], v[148:149], v[148:149], v[164:165]
  v_pk_fma_f32 v[166:167], v[150:151], v[150:151], v[166:167]
  v_cvt_pk_bf16_f32 v152, v136, v137
  v_cvt_pk_bf16_f32 v153, v138, v139
  v_cvt_pk_bf16_f32 v154, v140, v141
  v_cvt_pk_bf16_f32 v155, v142, v143
  v_cvt_pk_bf16_f32 v156, v144, v145
  v_cvt_pk_bf16_f32 v157, v146, v147
  v_cvt_pk_bf16_f32 v158, v148, v149
  v_cvt_pk_bf16_f32 v159, v150, v151
  ds_write_b128 v6, v[152:155] offset:4096
  ds_write_b128 v7, v[156:159] offset:4096
  s_waitcnt lgkmcnt(4)
  v_pk_fma_f32 v[136:137], v[120:121], v[120:121], s[74:75]
  v_pk_fma_f32 v[138:139], v[122:123], v[122:123], s[74:75]
  v_pk_fma_f32 v[140:141], v[124:125], v[124:125], s[74:75]
  v_pk_fma_f32 v[142:143], v[126:127], v[126:127], s[74:75]
  v_pk_fma_f32 v[144:145], v[128:129], v[128:129], s[74:75]
  v_pk_fma_f32 v[146:147], v[130:131], v[130:131], s[74:75]
  v_pk_fma_f32 v[148:149], v[132:133], v[132:133], s[74:75]
  v_pk_fma_f32 v[150:151], v[134:135], v[134:135], s[74:75]
  v_pk_mul_f32 v[136:137], v[120:121], v[136:137]
  v_pk_mul_f32 v[138:139], v[122:123], v[138:139]
  v_pk_mul_f32 v[140:141], v[124:125], v[140:141]
  v_pk_mul_f32 v[142:143], v[126:127], v[142:143]
  v_pk_mul_f32 v[144:145], v[128:129], v[144:145]
  v_pk_mul_f32 v[146:147], v[130:131], v[146:147]
  v_pk_mul_f32 v[148:149], v[132:133], v[148:149]
  v_pk_mul_f32 v[150:151], v[134:135], v[150:151]
  v_mfma_f32_32x32x16_bf16 v[104:119], v[32:35], a[144:147], 0
  v_exp_f32 v136, v136
  v_exp_f32 v137, v137
  v_exp_f32 v138, v138
  v_exp_f32 v139, v139
  v_exp_f32 v140, v140
  v_mfma_f32_32x32x16_bf16 v[104:119], v[36:39], a[148:151], v[104:119]
  v_exp_f32 v141, v141
  v_exp_f32 v142, v142
  v_exp_f32 v143, v143
  v_exp_f32 v144, v144
  v_exp_f32 v145, v145
  v_mfma_f32_32x32x16_bf16 v[104:119], v[40:43], a[152:155], v[104:119]
  v_exp_f32 v146, v146
  v_exp_f32 v147, v147
  v_exp_f32 v148, v148
  v_exp_f32 v149, v149
  v_exp_f32 v150, v150
  v_exp_f32 v151, v151
  v_pk_add_f32 v[136:137], v[136:137], 1.0 op_sel_hi:[1,0]
  v_pk_add_f32 v[138:139], v[138:139], 1.0 op_sel_hi:[1,0]
  v_pk_add_f32 v[140:141], v[140:141], 1.0 op_sel_hi:[1,0]
  v_pk_add_f32 v[142:143], v[142:143], 1.0 op_sel_hi:[1,0]
  v_pk_add_f32 v[144:145], v[144:145], 1.0 op_sel_hi:[1,0]
  v_pk_add_f32 v[146:147], v[146:147], 1.0 op_sel_hi:[1,0]
  v_pk_add_f32 v[148:149], v[148:149], 1.0 op_sel_hi:[1,0]
  v_pk_add_f32 v[150:151], v[150:151], 1.0 op_sel_hi:[1,0]
  v_mfma_f32_32x32x16_bf16 v[104:119], v[44:47], a[156:159], v[104:119]
  v_rcp_f32 v136, v136
  v_rcp_f32 v137, v137
  v_rcp_f32 v138, v138
  v_rcp_f32 v139, v139
  v_rcp_f32 v140, v140
  v_mfma_f32_32x32x16_bf16 v[104:119], v[48:51], a[160:163], v[104:119]
  v_rcp_f32 v141, v141
  v_rcp_f32 v142, v142
  v_rcp_f32 v143, v143
  v_rcp_f32 v144, v144
  v_rcp_f32 v145, v145
  v_mfma_f32_32x32x16_bf16 v[104:119], v[52:55], a[164:167], v[104:119]
  v_rcp_f32 v146, v146
  v_rcp_f32 v147, v147
  v_rcp_f32 v148, v148
  v_rcp_f32 v149, v149
  v_rcp_f32 v150, v150
  v_rcp_f32 v151, v151
  v_pk_mul_f32 v[136:137], v[120:121], v[136:137]
  v_pk_mul_f32 v[138:139], v[122:123], v[138:139]
  v_pk_mul_f32 v[140:141], v[124:125], v[140:141]
  v_pk_mul_f32 v[142:143], v[126:127], v[142:143]
  v_pk_mul_f32 v[144:145], v[128:129], v[144:145]
  v_pk_mul_f32 v[146:147], v[130:131], v[146:147]
  v_pk_mul_f32 v[148:149], v[132:133], v[148:149]
  v_pk_mul_f32 v[150:151], v[134:135], v[150:151]
  v_pk_fma_f32 v[168:169], v[136:137], v[136:137], v[168:169]
  v_pk_fma_f32 v[170:171], v[138:139], v[138:139], v[170:171]
  v_pk_fma_f32 v[168:169], v[140:141], v[140:141], v[168:169]
  v_pk_fma_f32 v[170:171], v[142:143], v[142:143], v[170:171]
  v_pk_fma_f32 v[168:169], v[144:145], v[144:145], v[168:169]
  v_pk_fma_f32 v[170:171], v[146:147], v[146:147], v[170:171]
  v_pk_fma_f32 v[168:169], v[148:149], v[148:149], v[168:169]
  v_pk_fma_f32 v[170:171], v[150:151], v[150:151], v[170:171]
  s_waitcnt vmcnt(0)
  v_cvt_pk_bf16_f32 v152, v136, v137
  v_mfma_f32_16x16x32_bf16 v[80:83], v[172:175], v[250:253], 0
  v_cvt_pk_bf16_f32 v153, v138, v139
  v_mfma_f32_16x16x32_bf16 v[84:87], v[176:179], v[250:253], 0
  v_cvt_pk_bf16_f32 v154, v140, v141
  v_mfma_f32_16x16x32_bf16 v[88:91], v[180:183], v[250:253], 0
  v_cvt_pk_bf16_f32 v155, v142, v143
  v_mfma_f32_16x16x32_bf16 v[92:95], v[184:187], v[250:253], 0
  v_cvt_pk_bf16_f32 v156, v144, v145
  v_cvt_pk_bf16_f32 v157, v146, v147
  v_cvt_pk_bf16_f32 v158, v148, v149
  v_cvt_pk_bf16_f32 v159, v150, v151
  v_mfma_f32_16x16x32_bf16 v[96:99], v[188:191], v[250:253], 0
  v_mfma_f32_16x16x32_bf16 v[100:103], v[192:195], v[250:253], 0
  ds_write_b128 v6, v[152:155] offset:8192
  ds_write_b128 v7, v[156:159] offset:8192
  v_mov_b32 v16, 1
  s_mov_b64 exec, 1
  ds_write_b32 v29, v16
  s_mov_b64 exec, -1
  v_pk_fma_f32 v[136:137], v[104:105], v[104:105], s[74:75]
  v_pk_fma_f32 v[138:139], v[106:107], v[106:107], s[74:75]
  v_pk_fma_f32 v[140:141], v[108:109], v[108:109], s[74:75]
  v_pk_fma_f32 v[142:143], v[110:111], v[110:111], s[74:75]
  v_pk_fma_f32 v[144:145], v[112:113], v[112:113], s[74:75]
  v_pk_fma_f32 v[146:147], v[114:115], v[114:115], s[74:75]
  v_pk_fma_f32 v[148:149], v[116:117], v[116:117], s[74:75]
  v_pk_fma_f32 v[150:151], v[118:119], v[118:119], s[74:75]
  v_pk_mul_f32 v[136:137], v[104:105], v[136:137]
  v_pk_mul_f32 v[138:139], v[106:107], v[138:139]
  v_pk_mul_f32 v[140:141], v[108:109], v[140:141]
  v_pk_mul_f32 v[142:143], v[110:111], v[142:143]
  v_pk_mul_f32 v[144:145], v[112:113], v[144:145]
  v_pk_mul_f32 v[146:147], v[114:115], v[146:147]
  v_pk_mul_f32 v[148:149], v[116:117], v[148:149]
  v_pk_mul_f32 v[150:151], v[118:119], v[150:151]
  v_mfma_f32_32x32x16_bf16 v[120:135], v[32:35], a[168:171], 0
  v_exp_f32 v136, v136
  v_exp_f32 v137, v137
  v_exp_f32 v138, v138
  v_exp_f32 v139, v139
  v_exp_f32 v140, v140
  v_mfma_f32_32x32x16_bf16 v[120:135], v[36:39], a[172:175], v[120:135]
  v_exp_f32 v141, v141
  v_exp_f32 v142, v142
  v_exp_f32 v143, v143
  v_exp_f32 v144, v144
  v_exp_f32 v145, v145
  v_mfma_f32_32x32x16_bf16 v[120:135], v[40:43], a[176:179], v[120:135]
  v_exp_f32 v146, v146
  v_exp_f32 v147, v147
  v_exp_f32 v148, v148
  v_exp_f32 v149, v149
  v_exp_f32 v150, v150
  v_exp_f32 v151, v151
  v_pk_add_f32 v[136:137], v[136:137], 1.0 op_sel_hi:[1,0]
  v_pk_add_f32 v[138:139], v[138:139], 1.0 op_sel_hi:[1,0]
  v_pk_add_f32 v[140:141], v[140:141], 1.0 op_sel_hi:[1,0]
  v_pk_add_f32 v[142:143], v[142:143], 1.0 op_sel_hi:[1,0]
  v_pk_add_f32 v[144:145], v[144:145], 1.0 op_sel_hi:[1,0]
  v_pk_add_f32 v[146:147], v[146:147], 1.0 op_sel_hi:[1,0]
  v_pk_add_f32 v[148:149], v[148:149], 1.0 op_sel_hi:[1,0]
  v_pk_add_f32 v[150:151], v[150:151], 1.0 op_sel_hi:[1,0]
  v_mfma_f32_32x32x16_bf16 v[120:135], v[44:47], a[180:183], v[120:135]
  v_rcp_f32 v136, v136
  v_rcp_f32 v137, v137
  v_rcp_f32 v138, v138
  v_rcp_f32 v139, v139
  v_rcp_f32 v140, v140
  v_mfma_f32_32x32x16_bf16 v[120:135], v[48:51], a[184:187], v[120:135]
  v_rcp_f32 v141, v141
  v_rcp_f32 v142, v142
  v_rcp_f32 v143, v143
  v_rcp_f32 v144, v144
  v_rcp_f32 v145, v145
  v_mfma_f32_32x32x16_bf16 v[120:135], v[52:55], a[188:191], v[120:135]
  v_rcp_f32 v146, v146
  v_rcp_f32 v147, v147
  v_rcp_f32 v148, v148
  v_rcp_f32 v149, v149
  v_rcp_f32 v150, v150
  v_rcp_f32 v151, v151
  ds_read_b128 v[18:21], v17
  v_pk_mul_f32 v[136:137], v[104:105], v[136:137]
  v_pk_mul_f32 v[138:139], v[106:107], v[138:139]
  v_pk_mul_f32 v[140:141], v[108:109], v[140:141]
  v_pk_mul_f32 v[142:143], v[110:111], v[142:143]
  v_pk_mul_f32 v[144:145], v[112:113], v[144:145]
  v_pk_mul_f32 v[146:147], v[114:115], v[146:147]
  v_pk_mul_f32 v[148:149], v[116:117], v[148:149]
  v_pk_mul_f32 v[150:151], v[118:119], v[150:151]
  v_pk_fma_f32 v[160:161], v[136:137], v[136:137], v[160:161]
  v_pk_fma_f32 v[162:163], v[138:139], v[138:139], v[162:163]
  v_pk_fma_f32 v[160:161], v[140:141], v[140:141], v[160:161]
  v_pk_fma_f32 v[162:163], v[142:143], v[142:143], v[162:163]
  v_pk_fma_f32 v[160:161], v[144:145], v[144:145], v[160:161]
  v_pk_fma_f32 v[162:163], v[146:147], v[146:147], v[162:163]
  v_pk_fma_f32 v[160:161], v[148:149], v[148:149], v[160:161]
  v_pk_fma_f32 v[162:163], v[150:151], v[150:151], v[162:163]
  v_cvt_pk_bf16_f32 v152, v136, v137
  v_cvt_pk_bf16_f32 v153, v138, v139
  v_cvt_pk_bf16_f32 v154, v140, v141
  v_cvt_pk_bf16_f32 v155, v142, v143
  v_cvt_pk_bf16_f32 v156, v144, v145
  v_cvt_pk_bf16_f32 v157, v146, v147
  v_cvt_pk_bf16_f32 v158, v148, v149
  v_cvt_pk_bf16_f32 v159, v150, v151
  s_waitcnt lgkmcnt(0)
  v_min_u32 v18, v18, v19
  v_min3_u32 v18, v18, v20, v21
  v_cmp_gt_u32 vcc, 1, v18
  s_cbranch_vccz L_fw1_ok
L_fw1:
  ds_read_b128 v[18:21], v17
  s_waitcnt lgkmcnt(0)
  v_min_u32 v18, v18, v19
  v_min3_u32 v18, v18, v20, v21
  v_cmp_gt_u32 vcc, 1, v18
  s_cbranch_vccnz L_fw1
L_fw1_ok:
  ds_read_b128 v[56:59], v2 offset:19968
  ds_read_b128 v[60:63], v2 offset:20000
  ds_read_b128 v[64:67], v2 offset:20032
  ds_read_b128 v[68:71], v2 offset:20064
  ds_read_b128 v[72:75], v2 offset:20096
  ds_read_b128 v[76:79], v2 offset:20128
  ds_read_b64_tr_b16 a[0:1], v8 offset:0
  ds_read_b64_tr_b16 a[2:3], v8 offset:1024
  ds_read_b64_tr_b16 a[4:5], v8 offset:4096
  ds_read_b64_tr_b16 a[6:7], v8 offset:5120
  ds_write_b128 v4, v[152:155] offset:49152
  ds_write_b128 v5, v[156:159] offset:49152
  buffer_load_dwordx4 v[196:199], v23, s[44:47], s11 offen offset:0 sc1
  buffer_load_dwordx4 v[200:203], v23, s[44:47], s11 offen offset:1024 sc1
  v_pk_fma_f32 v[136:137], v[120:121], v[120:121], s[74:75]
  v_pk_fma_f32 v[138:139], v[122:123], v[122:123], s[74:75]
  v_pk_fma_f32 v[140:141], v[124:125], v[124:125], s[74:75]
  v_pk_fma_f32 v[142:143], v[126:127], v[126:127], s[74:75]
  v_pk_fma_f32 v[144:145], v[128:129], v[128:129], s[74:75]
  v_pk_fma_f32 v[146:147], v[130:131], v[130:131], s[74:75]
  v_pk_fma_f32 v[148:149], v[132:133], v[132:133], s[74:75]
  v_pk_fma_f32 v[150:151], v[134:135], v[134:135], s[74:75]
  v_pk_mul_f32 v[136:137], v[120:121], v[136:137]
  v_pk_mul_f32 v[138:139], v[122:123], v[138:139]
  v_pk_mul_f32 v[140:141], v[124:125], v[140:141]
  v_pk_mul_f32 v[142:143], v[126:127], v[142:143]
  v_pk_mul_f32 v[144:145], v[128:129], v[144:145]
  v_pk_mul_f32 v[146:147], v[130:131], v[146:147]
  v_pk_mul_f32 v[148:149], v[132:133], v[148:149]
  v_pk_mul_f32 v[150:151], v[134:135], v[150:151]
  v_mfma_f32_32x32x16_bf16 v[104:119], v[32:35], a[192:195], 0
  v_exp_f32 v136, v136
  v_exp_f32 v137, v137
  v_exp_f32 v138, v138
  v_exp_f32 v139, v139
  v_exp_f32 v140, v140
  v_mfma_f32_32x32x16_bf16 v[104:119], v[36:39], a[196:199], v[104:119]
  v_exp_f32 v141, v141
  v_exp_f32 v142, v142
  v_exp_f32 v143, v143
  v_exp_f32 v144, v144
  v_exp_f32 v145, v145
  v_mfma_f32_32x32x16_bf16 v[104:119], v[40:43], a[200:203], v[104:119]
  v_exp_f32 v146, v146
  v_exp_f32 v147, v147
  v_exp_f32 v148, v148
  v_exp_f32 v149, v149
  v_exp_f32 v150, v150
  v_exp_f32 v151, v151
  v_pk_add_f32 v[136:137], v[136:137], 1.0 op_sel_hi:[1,0]
  v_pk_add_f32 v[138:139], v[138:139], 1.0 op_sel_hi:[1,0]
  v_pk_add_f32 v[140:141], v[140:141], 1.0 op_sel_hi:[1,0]
  v_pk_add_f32 v[142:143], v[142:143], 1.0 op_sel_hi:[1,0]
  v_pk_add_f32 v[144:145], v[144:145], 1.0 op_sel_hi:[1,0]
  v_pk_add_f32 v[146:147], v[146:147], 1.0 op_sel_hi:[1,0]
  v_pk_add_f32 v[148:149], v[148:149], 1.0 op_sel_hi:[1,0]
  v_pk_add_f32 v[150:151], v[150:151], 1.0 op_sel_hi:[1,0]
  v_mfma_f32_32x32x16_bf16 v[104:119], v[44:47], a[204:207], v[104:119]
  v_rcp_f32 v136, v136
  v_rcp_f32 v137, v137
  v_rcp_f32 v138, v138
  v_rcp_f32 v139, v139
  v_rcp_f32 v140, v140
  v_mfma_f32_32x32x16_bf16 v[104:119], v[48:51], a[208:211], v[104:119]
  v_rcp_f32 v141, v141
  v_rcp_f32 v142, v142
  v_rcp_f32 v143, v143
  v_rcp_f32 v144, v144
  v_rcp_f32 v145, v145
  v_mfma_f32_32x32x16_bf16 v[104:119], v[52:55], a[212:215], v[104:119]
  v_rcp_f32 v146, v146
  v_rcp_f32 v147, v147
  v_rcp_f32 v148, v148
  v_rcp_f32 v149, v149
  v_rcp_f32 v150, v150
  v_rcp_f32 v151, v151
  v_pk_mul_f32 v[136:137], v[120:121], v[136:137]
  v_pk_mul_f32 v[138:139], v[122:123], v[138:139]
  v_pk_mul_f32 v[140:141], v[124:125], v[140:141]
  v_pk_mul_f32 v[142:143], v[126:127], v[142:143]
  v_pk_mul_f32 v[144:145], v[128:129], v[144:145]
  v_pk_mul_f32 v[146:147], v[130:131], v[146:147]
  v_pk_mul_f32 v[148:149], v[132:133], v[148:149]
  v_pk_mul_f32 v[150:151], v[134:135], v[150:151]
  v_pk_fma_f32 v[164:165], v[136:137], v[136:137], v[164:165]
  v_pk_fma_f32 v[166:167], v[138:139], v[138:139], v[166:167]
  v_pk_fma_f32 v[164:165], v[140:141], v[140:141], v[164:165]
  v_pk_fma_f32 v[166:167], v[142:143], v[142:143], v[166:167]
  v_pk_fma_f32 v[164:165], v[144:145], v[144:145], v[164:165]
  v_pk_fma_f32 v[166:167], v[146:147], v[146:147], v[166:167]
  v_pk_fma_f32 v[164:165], v[148:149], v[148:149], v[164:165]
  v_pk_fma_f32 v[166:167], v[150:151], v[150:151], v[166:167]
  v_cvt_pk_bf16_f32 v152, v136, v137
  v_cvt_pk_bf16_f32 v153, v138, v139
  v_cvt_pk_bf16_f32 v154, v140, v141
  v_cvt_pk_bf16_f32 v155, v142, v143
  v_cvt_pk_bf16_f32 v156, v144, v145
  v_cvt_pk_bf16_f32 v157, v146, v147
  v_cvt_pk_bf16_f32 v158, v148, v149
  v_cvt_pk_bf16_f32 v159, v150, v151
  ds_read_b64_tr_b16 a[8:9], v8 offset:8192
  ds_read_b64_tr_b16 a[10:11], v8 offset:9216
  ds_read_b64_tr_b16 a[12:13], v8 offset:12288
  ds_read_b64_tr_b16 a[14:15], v8 offset:13312
  ds_write_b128 v4, v[152:155] offset:53248
  ds_write_b128 v5, v[156:159] offset:53248
  buffer_load_dwordx4 v[204:207], v23, s[44:47], s11 offen offset:2048 sc1
  buffer_load_dwordx4 v[208:211], v23, s[44:47], s11 offen offset:3072 sc1
  buffer_load_dwordx2 v[250:251], v28, s[56:59], 0 offen offset:64
  buffer_load_dwordx2 v[252:253], v28, s[56:59], 0 offen offset:80
  s_waitcnt lgkmcnt(12)
  v_pk_fma_f32 v[136:137], v[104:105], v[104:105], s[74:75]
  v_pk_fma_f32 v[138:139], v[106:107], v[106:107], s[74:75]
  v_pk_fma_f32 v[140:141], v[108:109], v[108:109], s[74:75]
  v_pk_fma_f32 v[142:143], v[110:111], v[110:111], s[74:75]
  v_pk_fma_f32 v[144:145], v[112:113], v[112:113], s[74:75]
  v_pk_fma_f32 v[146:147], v[114:115], v[114:115], s[74:75]
  v_pk_fma_f32 v[148:149], v[116:117], v[116:117], s[74:75]
  v_pk_fma_f32 v[150:151], v[118:119], v[118:119], s[74:75]
  v_pk_mul_f32 v[136:137], v[104:105], v[136:137]
  v_pk_mul_f32 v[138:139], v[106:107], v[138:139]
  v_pk_mul_f32 v[140:141], v[108:109], v[140:141]
  v_pk_mul_f32 v[142:143], v[110:111], v[142:143]
  v_pk_mul_f32 v[144:145], v[112:113], v[144:145]
  v_pk_mul_f32 v[146:147], v[114:115], v[146:147]
  v_pk_mul_f32 v[148:149], v[116:117], v[148:149]
  v_pk_mul_f32 v[150:151], v[118:119], v[150:151]
  v_mfma_f32_32x32x16_bf16 v[120:135], v[56:59], a[144:147], 0
  v_exp_f32 v136, v136
  v_exp_f32 v137, v137
  v_exp_f32 v138, v138
  v_exp_f32 v139, v139
  v_exp_f32 v140, v140
  v_mfma_f32_32x32x16_bf16 v[120:135], v[60:63], a[148:151], v[120:135]
  v_exp_f32 v141, v141
  v_exp_f32 v142, v142
  v_exp_f32 v143, v143
  v_exp_f32 v144, v144
  v_exp_f32 v145, v145
  v_mfma_f32_32x32x16_bf16 v[120:135], v[64:67], a[152:155], v[120:135]
  v_exp_f32 v146, v146
  v_exp_f32 v147, v147
  v_exp_f32 v148, v148
  v_exp_f32 v149, v149
  v_exp_f32 v150, v150
  v_exp_f32 v151, v151
  v_pk_add_f32 v[136:137], v[136:137], 1.0 op_sel_hi:[1,0]
  v_pk_add_f32 v[138:139], v[138:139], 1.0 op_sel_hi:[1,0]
  v_pk_add_f32 v[140:141], v[140:141], 1.0 op_sel_hi:[1,0]
  v_pk_add_f32 v[142:143], v[142:143], 1.0 op_sel_hi:[1,0]
  v_pk_add_f32 v[144:145], v[144:145], 1.0 op_sel_hi:[1,0]
  v_pk_add_f32 v[146:147], v[146:147], 1.0 op_sel_hi:[1,0]
  v_pk_add_f32 v[148:149], v[148:149], 1.0 op_sel_hi:[1,0]
  v_pk_add_f32 v[150:151], v[150:151], 1.0 op_sel_hi:[1,0]
  v_mfma_f32_32x32x16_bf16 v[120:135], v[68:71], a[156:159], v[120:135]
  v_rcp_f32 v136, v136
  v_rcp_f32 v137, v137
  v_rcp_f32 v138, v138
  v_rcp_f32 v139, v139
  v_rcp_f32 v140, v140
  v_mfma_f32_32x32x16_bf16 v[120:135], v[72:75], a[160:163], v[120:135]
  v_rcp_f32 v141, v141
  v_rcp_f32 v142, v142
  v_rcp_f32 v143, v143
  v_rcp_f32 v144, v144
  v_rcp_f32 v145, v145
  v_mfma_f32_32x32x16_bf16 v[120:135], v[76:79], a[164:167], v[120:135]
  v_rcp_f32 v146, v146
  v_rcp_f32 v147, v147
  v_rcp_f32 v148, v148
  v_rcp_f32 v149, v149
  v_rcp_f32 v150, v150
  v_rcp_f32 v151, v151
  v_pk_mul_f32 v[136:137], v[104:105], v[136:137]
  v_pk_mul_f32 v[138:139], v[106:107], v[138:139]
  v_pk_mul_f32 v[140:141], v[108:109], v[140:141]
  v_pk_mul_f32 v[142:143], v[110:111], v[142:143]
  v_pk_mul_f32 v[144:145], v[112:113], v[144:145]
  v_pk_mul_f32 v[146:147], v[114:115], v[146:147]
  v_pk_mul_f32 v[148:149], v[116:117], v[148:149]
  v_pk_mul_f32 v[150:151], v[118:119], v[150:151]
  v_pk_fma_f32 v[168:169], v[136:137], v[136:137], v[168:169]
  v_pk_fma_f32 v[170:171], v[138:139], v[138:139], v[170:171]
  v_pk_fma_f32 v[168:169], v[140:141], v[140:141], v[168:169]
  v_pk_fma_f32 v[170:171], v[142:143], v[142:143], v[170:171]
  v_pk_fma_f32 v[168:169], v[144:145], v[144:145], v[168:169]
  v_pk_fma_f32 v[170:171], v[146:147], v[146:147], v[170:171]
  v_pk_fma_f32 v[168:169], v[148:149], v[148:149], v[168:169]
  v_pk_fma_f32 v[170:171], v[150:151], v[150:151], v[170:171]
  v_cvt_pk_bf16_f32 v152, v136, v137
  v_cvt_pk_bf16_f32 v153, v138, v139
  v_cvt_pk_bf16_f32 v154, v140, v141
  v_cvt_pk_bf16_f32 v155, v142, v143
  v_cvt_pk_bf16_f32 v156, v144, v145
  v_cvt_pk_bf16_f32 v157, v146, v147
  v_cvt_pk_bf16_f32 v158, v148, v149
  v_cvt_pk_bf16_f32 v159, v150, v151
  ds_read_b64_tr_b16 a[16:17], v8 offset:16384
  ds_read_b64_tr_b16 a[18:19], v8 offset:17408
  ds_read_b64_tr_b16 a[20:21], v8 offset:20480
  ds_read_b64_tr_b16 a[22:23], v8 offset:21504
  ds_write_b128 v4, v[152:155] offset:57344
  ds_write_b128 v5, v[156:159] offset:57344
  buffer_load_dwordx4 v[212:215], v23, s[44:47], s13 offen offset:0 sc1
  buffer_load_dwordx4 v[216:219], v23, s[44:47], s13 offen offset:1024 sc1
  s_add_u32 s11, s11, 6144
  s_add_u32 s13, s13, 6144
  v_pk_fma_f32 v[136:137], v[120:121], v[120:121], s[74:75]
  v_pk_fma_f32 v[138:139], v[122:123], v[122:123], s[74:75]
  v_pk_fma_f32 v[140:141], v[124:125], v[124:125], s[74:75]
  v_pk_fma_f32 v[142:143], v[126:127], v[126:127], s[74:75]
  v_pk_fma_f32 v[144:145], v[128:129], v[128:129], s[74:75]
  v_pk_fma_f32 v[146:147], v[130:131], v[130:131], s[74:75]
  v_pk_fma_f32 v[148:149], v[132:133], v[132:133], s[74:75]
  v_pk_fma_f32 v[150:151], v[134:135], v[134:135], s[74:75]
  v_pk_mul_f32 v[136:137], v[120:121], v[136:137]
  v_pk_mul_f32 v[138:139], v[122:123], v[138:139]
  v_pk_mul_f32 v[140:141], v[124:125], v[140:141]
  v_pk_mul_f32 v[142:143], v[126:127], v[142:143]
  v_pk_mul_f32 v[144:145], v[128:129], v[144:145]
  v_pk_mul_f32 v[146:147], v[130:131], v[146:147]
  v_pk_mul_f32 v[148:149], v[132:133], v[148:149]
  v_pk_mul_f32 v[150:151], v[134:135], v[150:151]
  v_mfma_f32_32x32x16_bf16 v[104:119], v[56:59], a[168:171], 0
  v_exp_f32 v136, v136
  v_exp_f32 v137, v137
  v_exp_f32 v138, v138
  v_exp_f32 v139, v139
  v_exp_f32 v140, v140
  v_mfma_f32_32x32x16_bf16 v[104:119], v[60:63], a[172:175], v[104:119]
  v_exp_f32 v141, v141
  v_exp_f32 v142, v142
  v_exp_f32 v143, v143
  v_exp_f32 v144, v144
  v_exp_f32 v145, v145
  v_mfma_f32_32x32x16_bf16 v[104:119], v[64:67], a[176:179], v[104:119]
  v_exp_f32 v146, v146
  v_exp_f32 v147, v147
  v_exp_f32 v148, v148
  v_exp_f32 v149, v149
  v_exp_f32 v150, v150
  v_exp_f32 v151, v151
  v_pk_add_f32 v[136:137], v[136:137], 1.0 op_sel_hi:[1,0]
  v_pk_add_f32 v[138:139], v[138:139], 1.0 op_sel_hi:[1,0]
  v_pk_add_f32 v[140:141], v[140:141], 1.0 op_sel_hi:[1,0]
  v_pk_add_f32 v[142:143], v[142:143], 1.0 op_sel_hi:[1,0]
  v_pk_add_f32 v[144:145], v[144:145], 1.0 op_sel_hi:[1,0]
  v_pk_add_f32 v[146:147], v[146:147], 1.0 op_sel_hi:[1,0]
  v_pk_add_f32 v[148:149], v[148:149], 1.0 op_sel_hi:[1,0]
  v_pk_add_f32 v[150:151], v[150:151], 1.0 op_sel_hi:[1,0]
  v_mfma_f32_32x32x16_bf16 v[104:119], v[68:71], a[180:183], v[104:119]
  v_rcp_f32 v136, v136
  v_rcp_f32 v137, v137
  v_rcp_f32 v138, v138
  v_rcp_f32 v139, v139
  v_rcp_f32 v140, v140
  v_mfma_f32_32x32x16_bf16 v[104:119], v[72:75], a[184:187], v[104:119]
  v_rcp_f32 v141, v141
  v_rcp_f32 v142, v142
  v_rcp_f32 v143, v143
  v_rcp_f32 v144, v144
  v_rcp_f32 v145, v145
  v_mfma_f32_32x32x16_bf16 v[104:119], v[76:79], a[188:191], v[104:119]
  v_rcp_f32 v146, v146
  v_rcp_f32 v147, v147
  v_rcp_f32 v148, v148
  v_rcp_f32 v149, v149
  v_rcp_f32 v150, v150
  v_rcp_f32 v151, v151
  v_pk_mul_f32 v[136:137], v[120:121], v[136:137]
  v_pk_mul_f32 v[138:139], v[122:123], v[138:139]
  v_pk_mul_f32 v[140:141], v[124:125], v[140:141]
  v_pk_mul_f32 v[142:143], v[126:127], v[142:143]
  v_pk_mul_f32 v[144:145], v[128:129], v[144:145]
  v_pk_mul_f32 v[146:147], v[130:131], v[146:147]
  v_pk_mul_f32 v[148:149], v[132:133], v[148:149]
  v_pk_mul_f32 v[150:151], v[134:135], v[150:151]
  v_pk_fma_f32 v[160:161], v[136:137], v[136:137], v[160:161]
  v_pk_fma_f32 v[162:163], v[138:139], v[138:139], v[162:163]
  v_pk_fma_f32 v[160:161], v[140:141], v[140:141], v[160:161]
  v_pk_fma_f32 v[162:163], v[142:143], v[142:143], v[162:163]
  v_pk_fma_f32 v[160:161], v[144:145], v[144:145], v[160:161]
  v_pk_fma_f32 v[162:163], v[146:147], v[146:147], v[162:163]
  v_pk_fma_f32 v[160:161], v[148:149], v[148:149], v[160:161]
  v_pk_fma_f32 v[162:163], v[150:151], v[150:151], v[162:163]
  v_cvt_pk_bf16_f32 v152, v136, v137
  v_cvt_pk_bf16_f32 v153, v138, v139
  v_cvt_pk_bf16_f32 v154, v140, v141
  v_cvt_pk_bf16_f32 v155, v142, v143
  v_cvt_pk_bf16_f32 v156, v144, v145
  v_cvt_pk_bf16_f32 v157, v146, v147
  v_cvt_pk_bf16_f32 v158, v148, v149
  v_cvt_pk_bf16_f32 v159, v150, v151
  ds_read_b128 v[32:35], v2 offset:26624
  ds_read_b128 v[36:39], v2 offset:26656
  ds_read_b128 v[40:43], v2 offset:26688
  ds_read_b128 v[44:47], v2 offset:26720
  ds_read_b128 v[48:51], v2 offset:26752
  ds_read_b128 v[52:55], v2 offset:26784
  ds_read_b128 a[216:219], v3 offset:0
  ds_read_b128 a[220:223], v3 offset:32
  ds_read_b128 a[224:227], v3 offset:64
  ds_read_b128 a[228:231], v3 offset:96
  ds_read_b128 a[232:235], v3 offset:128
  ds_read_b128 a[236:239], v3 offset:160
  ds_read_b64_tr_b16 a[24:25], v8 offset:24576
  ds_read_b64_tr_b16 a[26:27], v8 offset:25600
  ds_read_b64_tr_b16 a[28:29], v8 offset:28672
  ds_read_b64_tr_b16 a[30:31], v8 offset:29696
  ds_write_b128 v6, v[152:155] offset:49152
  ds_write_b128 v7, v[156:159] offset:49152
  v_pk_fma_f32 v[136:137], v[104:105], v[104:105], s[74:75]
  v_pk_fma_f32 v[138:139], v[106:107], v[106:107], s[74:75]
  v_pk_fma_f32 v[140:141], v[108:109], v[108:109], s[74:75]
  v_pk_fma_f32 v[142:143], v[110:111], v[110:111], s[74:75]
  v_pk_fma_f32 v[144:145], v[112:113], v[112:113], s[74:75]
  v_pk_fma_f32 v[146:147], v[114:115], v[114:115], s[74:75]
  v_pk_fma_f32 v[148:149], v[116:117], v[116:117], s[74:75]
  v_pk_fma_f32 v[150:151], v[118:119], v[118:119], s[74:75]
  v_pk_mul_f32 v[136:137], v[104:105], v[136:137]
  v_pk_mul_f32 v[138:139], v[106:107], v[138:139]
  v_pk_mul_f32 v[140:141], v[108:109], v[140:141]
  v_pk_mul_f32 v[142:143], v[110:111], v[142:143]
  v_pk_mul_f32 v[144:145], v[112:113], v[144:145]
  v_pk_mul_f32 v[146:147], v[114:115], v[146:147]
  v_pk_mul_f32 v[148:149], v[116:117], v[148:149]
  v_pk_mul_f32 v[150:151], v[118:119], v[150:151]
  v_mfma_f32_32x32x16_bf16 v[120:135], v[56:59], a[192:195], 0
  v_exp_f32 v136, v136
  v_exp_f32 v137, v137
  v_exp_f32 v138, v138
  v_exp_f32 v139, v139
  v_exp_f32 v140, v140
  v_mfma_f32_32x32x16_bf16 v[120:135], v[60:63], a[196:199], v[120:135]
  v_exp_f32 v141, v141
  v_exp_f32 v142, v142
  v_exp_f32 v143, v143
  v_exp_f32 v144, v144
  v_exp_f32 v145, v145
  v_mfma_f32_32x32x16_bf16 v[120:135], v[64:67], a[200:203], v[120:135]
  v_exp_f32 v146, v146
  v_exp_f32 v147, v147
  v_exp_f32 v148, v148
  v_exp_f32 v149, v149
  v_exp_f32 v150, v150
  v_exp_f32 v151, v151
  v_pk_add_f32 v[136:137], v[136:137], 1.0 op_sel_hi:[1,0]
  v_pk_add_f32 v[138:139], v[138:139], 1.0 op_sel_hi:[1,0]
  v_pk_add_f32 v[140:141], v[140:141], 1.0 op_sel_hi:[1,0]
  v_pk_add_f32 v[142:143], v[142:143], 1.0 op_sel_hi:[1,0]
  v_pk_add_f32 v[144:145], v[144:145], 1.0 op_sel_hi:[1,0]
  v_pk_add_f32 v[146:147], v[146:147], 1.0 op_sel_hi:[1,0]
  v_pk_add_f32 v[148:149], v[148:149], 1.0 op_sel_hi:[1,0]
  v_pk_add_f32 v[150:151], v[150:151], 1.0 op_sel_hi:[1,0]
  v_mfma_f32_32x32x16_bf16 v[120:135], v[68:71], a[204:207], v[120:135]
  v_rcp_f32 v136, v136
  v_rcp_f32 v137, v137
  v_rcp_f32 v138, v138
  v_rcp_f32 v139, v139
  v_rcp_f32 v140, v140
  v_mfma_f32_32x32x16_bf16 v[120:135], v[72:75], a[208:211], v[120:135]
  v_rcp_f32 v141, v141
  v_rcp_f32 v142, v142
  v_rcp_f32 v143, v143
  v_rcp_f32 v144, v144
  v_rcp_f32 v145, v145
  v_mfma_f32_32x32x16_bf16 v[120:135], v[76:79], a[212:215], v[120:135]
  v_rcp_f32 v146, v146
  v_rcp_f32 v147, v147
  v_rcp_f32 v148, v148
  v_rcp_f32 v149, v149
  v_rcp_f32 v150, v150
  v_rcp_f32 v151, v151
  v_pk_mul_f32 v[136:137], v[104:105], v[136:137]
  v_pk_mul_f32 v[138:139], v[106:107], v[138:139]
  v_pk_mul_f32 v[140:141], v[108:109], v[140:141]
  v_pk_mul_f32 v[142:143], v[110:111], v[142:143]
  v_pk_mul_f32 v[144:145], v[112:113], v[144:145]
  v_pk_mul_f32 v[146:147], v[114:115], v[146:147]
  v_pk_mul_f32 v[148:149], v[116:117], v[148:149]
  v_pk_mul_f32 v[150:151], v[118:119], v[150:151]
  v_pk_fma_f32 v[164:165], v[136:137], v[136:137], v[164:165]
  v_pk_fma_f32 v[166:167], v[138:139], v[138:139], v[166:167]
  v_pk_fma_f32 v[164:165], v[140:141], v[140:141], v[164:165]
  v_pk_fma_f32 v[166:167], v[142:143], v[142:143], v[166:167]
  v_pk_fma_f32 v[164:165], v[144:145], v[144:145], v[164:165]
  v_pk_fma_f32 v[166:167], v[146:147], v[146:147], v[166:167]
  v_pk_fma_f32 v[164:165], v[148:149], v[148:149], v[164:165]
  v_pk_fma_f32 v[166:167], v[150:151], v[150:151], v[166:167]
  v_cvt_pk_bf16_f32 v152, v136, v137
  v_cvt_pk_bf16_f32 v153, v138, v139
  v_cvt_pk_bf16_f32 v154, v140, v141
  v_cvt_pk_bf16_f32 v155, v142, v143
  v_cvt_pk_bf16_f32 v156, v144, v145
  v_cvt_pk_bf16_f32 v157, v146, v147
  v_cvt_pk_bf16_f32 v158, v148, v149
  v_cvt_pk_bf16_f32 v159, v150, v151
  ds_read_b64_tr_b16 a[32:33], v8 offset:32768
  ds_read_b64_tr_b16 a[34:35], v8 offset:33792
  ds_read_b64_tr_b16 a[36:37], v8 offset:36864
  ds_read_b64_tr_b16 a[38:39], v8 offset:37888
  ds_write_b128 v6, v[152:155] offset:53248
  ds_write_b128 v7, v[156:159] offset:53248
  s_waitcnt lgkmcnt(15)
  s_waitcnt lgkmcnt(12)
  v_pk_fma_f32 v[136:137], v[120:121], v[120:121], s[74:75]
  v_pk_fma_f32 v[138:139], v[122:123], v[122:123], s[74:75]
  v_pk_fma_f32 v[140:141], v[124:125], v[124:125], s[74:75]
  v_pk_fma_f32 v[142:143], v[126:127], v[126:127], s[74:75]
  v_pk_fma_f32 v[144:145], v[128:129], v[128:129], s[74:75]
  v_pk_fma_f32 v[146:147], v[130:131], v[130:131], s[74:75]
  v_pk_fma_f32 v[148:149], v[132:133], v[132:133], s[74:75]
  v_pk_fma_f32 v[150:151], v[134:135], v[134:135], s[74:75]
  v_pk_mul_f32 v[136:137], v[120:121], v[136:137]
  v_pk_mul_f32 v[138:139], v[122:123], v[138:139]
  v_pk_mul_f32 v[140:141], v[124:125], v[140:141]
  v_pk_mul_f32 v[142:143], v[126:127], v[142:143]
  v_pk_mul_f32 v[144:145], v[128:129], v[144:145]
  v_pk_mul_f32 v[146:147], v[130:131], v[146:147]
  v_pk_mul_f32 v[148:149], v[132:133], v[148:149]
  v_pk_mul_f32 v[150:151], v[134:135], v[150:151]
  v_mfma_f32_32x32x16_bf16 v[104:119], v[32:35], a[144:147], 0
  v_exp_f32 v136, v136
  v_exp_f32 v137, v137
  v_exp_f32 v138, v138
  v_exp_f32 v139, v139
  v_exp_f32 v140, v140
  v_mfma_f32_32x32x16_bf16 v[104:119], v[36:39], a[148:151], v[104:119]
  v_exp_f32 v141, v141
  v_exp_f32 v142, v142
  v_exp_f32 v143, v143
  v_exp_f32 v144, v144
  v_exp_f32 v145, v145
  v_mfma_f32_32x32x16_bf16 v[104:119], v[40:43], a[152:155], v[104:119]
  v_exp_f32 v146, v146
  v_exp_f32 v147, v147
  v_exp_f32 v148, v148
  v_exp_f32 v149, v149
  v_exp_f32 v150, v150
  v_exp_f32 v151, v151
  v_pk_add_f32 v[136:137], v[136:137], 1.0 op_sel_hi:[1,0]
  v_pk_add_f32 v[138:139], v[138:139], 1.0 op_sel_hi:[1,0]
  v_pk_add_f32 v[140:141], v[140:141], 1.0 op_sel_hi:[1,0]
  v_pk_add_f32 v[142:143], v[142:143], 1.0 op_sel_hi:[1,0]
  v_pk_add_f32 v[144:145], v[144:145], 1.0 op_sel_hi:[1,0]
  v_pk_add_f32 v[146:147], v[146:147], 1.0 op_sel_hi:[1,0]
  v_pk_add_f32 v[148:149], v[148:149], 1.0 op_sel_hi:[1,0]
  v_pk_add_f32 v[150:151], v[150:151], 1.0 op_sel_hi:[1,0]
  v_mfma_f32_32x32x16_bf16 v[104:119], v[44:47], a[156:159], v[104:119]
  v_rcp_f32 v136, v136
  v_rcp_f32 v137, v137
  v_rcp_f32 v138, v138
  v_rcp_f32 v139, v139
  v_rcp_f32 v140, v140
  v_mfma_f32_32x32x16_bf16 v[104:119], v[48:51], a[160:163], v[104:119]
  v_rcp_f32 v141, v141
  v_rcp_f32 v142, v142
  v_rcp_f32 v143, v143
  v_rcp_f32 v144, v144
  v_rcp_f32 v145, v145
  v_mfma_f32_32x32x16_bf16 v[104:119], v[52:55], a[164:167], v[104:119]
  v_rcp_f32 v146, v146
  v_rcp_f32 v147, v147
  v_rcp_f32 v148, v148
  v_rcp_f32 v149, v149
  v_rcp_f32 v150, v150
  v_rcp_f32 v151, v151
  v_pk_mul_f32 v[136:137], v[120:121], v[136:137]
  v_pk_mul_f32 v[138:139], v[122:123], v[138:139]
  v_pk_mul_f32 v[140:141], v[124:125], v[140:141]
  v_pk_mul_f32 v[142:143], v[126:127], v[142:143]
  v_pk_mul_f32 v[144:145], v[128:129], v[144:145]
  v_pk_mul_f32 v[146:147], v[130:131], v[146:147]
  v_pk_mul_f32 v[148:149], v[132:133], v[148:149]
  v_pk_mul_f32 v[150:151], v[134:135], v[150:151]
  v_pk_fma_f32 v[168:169], v[136:137], v[136:137], v[168:169]
  v_pk_fma_f32 v[170:171], v[138:139], v[138:139], v[170:171]
  v_pk_fma_f32 v[168:169], v[140:141], v[140:141], v[168:169]
  v_pk_fma_f32 v[170:171], v[142:143], v[142:143], v[170:171]
  v_pk_fma_f32 v[168:169], v[144:145], v[144:145], v[168:169]
  v_pk_fma_f32 v[170:171], v[146:147], v[146:147], v[170:171]
  v_pk_fma_f32 v[168:169], v[148:149], v[148:149], v[168:169]
  v_pk_fma_f32 v[170:171], v[150:151], v[150:151], v[170:171]
  v_mfma_f32_32x32x16_bf16 a[240:255], a[216:219], a[144:147], 0
  v_mfma_f32_32x32x16_bf16 a[240:255], a[220:223], a[148:151], a[240:255]
  v_cvt_pk_bf16_f32 v152, v136, v137
  v_mfma_f32_32x32x16_bf16 a[240:255], a[224:227], a[152:155], a[240:255]
  s_waitcnt vmcnt(0)
  v_cvt_pk_bf16_f32 v153, v138, v139
  v_mfma_f32_16x16x32_bf16 v[80:83], v[196:199], v[250:253], v[80:83]
  v_mfma_f32_16x16x32_bf16 v[84:87], v[200:203], v[250:253], v[84:87]
  v_cvt_pk_bf16_f32 v154, v140, v141
  v_mfma_f32_16x16x32_bf16 v[88:91], v[204:207], v[250:253], v[88:91]
  v_mfma_f32_16x16x32_bf16 v[92:95], v[208:211], v[250:253], v[92:95]
  v_cvt_pk_bf16_f32 v155, v142, v143
  v_mfma_f32_16x16x32_bf16 v[96:99], v[212:215], v[250:253], v[96:99]
  v_cvt_pk_bf16_f32 v156, v144, v145
  v_cvt_pk_bf16_f32 v157, v146, v147
  v_cvt_pk_bf16_f32 v158, v148, v149
  v_cvt_pk_bf16_f32 v159, v150, v151
  v_mfma_f32_16x16x32_bf16 v[100:103], v[216:219], v[250:253], v[100:103]
  ds_read_b64_tr_b16 a[40:41], v8 offset:40960
  ds_read_b64_tr_b16 a[42:43], v8 offset:41984
  ds_read_b64_tr_b16 a[44:45], v8 offset:45056
  ds_read_b64_tr_b16 a[46:47], v8 offset:46080
  ds_write_b128 v6, v[152:155] offset:57344
  ds_write_b128 v7, v[156:159] offset:57344
  v_mov_b32 v16, 2
  s_mov_b64 exec, 1
  ds_write_b32 v29, v16
  s_mov_b64 exec, -1
  v_pk_fma_f32 v[136:137], v[104:105], v[104:105], s[74:75]
  v_pk_fma_f32 v[138:139], v[106:107], v[106:107], s[74:75]
  v_pk_fma_f32 v[140:141], v[108:109], v[108:109], s[74:75]
  v_pk_fma_f32 v[142:143], v[110:111], v[110:111], s[74:75]
  v_pk_fma_f32 v[144:145], v[112:113], v[112:113], s[74:75]
  v_pk_fma_f32 v[146:147], v[114:115], v[114:115], s[74:75]
  v_pk_fma_f32 v[148:149], v[116:117], v[116:117], s[74:75]
  v_pk_fma_f32 v[150:151], v[118:119], v[118:119], s[74:75]
  v_pk_mul_f32 v[136:137], v[104:105], v[136:137]
  v_pk_mul_f32 v[138:139], v[106:107], v[138:139]
  v_pk_mul_f32 v[140:141], v[108:109], v[140:141]
  v_pk_mul_f32 v[142:143], v[110:111], v[142:143]
  v_pk_mul_f32 v[144:145], v[112:113], v[144:145]
  v_pk_mul_f32 v[146:147], v[114:115], v[146:147]
  v_pk_mul_f32 v[148:149], v[116:117], v[148:149]
  v_pk_mul_f32 v[150:151], v[118:119], v[150:151]
  v_mfma_f32_32x32x16_bf16 v[120:135], v[32:35], a[168:171], 0
  v_exp_f32 v136, v136
  v_exp_f32 v137, v137
  v_exp_f32 v138, v138
  v_exp_f32 v139, v139
  v_exp_f32 v140, v140
  v_mfma_f32_32x32x16_bf16 v[120:135], v[36:39], a[172:175], v[120:135]
  v_exp_f32 v141, v141
  v_exp_f32 v142, v142
  v_exp_f32 v143, v143
  v_exp_f32 v144, v144
  v_exp_f32 v145, v145
  v_mfma_f32_32x32x16_bf16 v[120:135], v[40:43], a[176:179], v[120:135]
  v_exp_f32 v146, v146
  v_exp_f32 v147, v147
  v_exp_f32 v148, v148
  v_exp_f32 v149, v149
  v_exp_f32 v150, v150
  v_exp_f32 v151, v151
  v_pk_add_f32 v[136:137], v[136:137], 1.0 op_sel_hi:[1,0]
  v_pk_add_f32 v[138:139], v[138:139], 1.0 op_sel_hi:[1,0]
  v_pk_add_f32 v[140:141], v[140:141], 1.0 op_sel_hi:[1,0]
  v_pk_add_f32 v[142:143], v[142:143], 1.0 op_sel_hi:[1,0]
  v_pk_add_f32 v[144:145], v[144:145], 1.0 op_sel_hi:[1,0]
  v_pk_add_f32 v[146:147], v[146:147], 1.0 op_sel_hi:[1,0]
  v_pk_add_f32 v[148:149], v[148:149], 1.0 op_sel_hi:[1,0]
  v_pk_add_f32 v[150:151], v[150:151], 1.0 op_sel_hi:[1,0]
  v_mfma_f32_32x32x16_bf16 v[120:135], v[44:47], a[180:183], v[120:135]
  v_rcp_f32 v136, v136
  v_rcp_f32 v137, v137
  v_rcp_f32 v138, v138
  v_rcp_f32 v139, v139
  v_rcp_f32 v140, v140
  v_mfma_f32_32x32x16_bf16 v[120:135], v[48:51], a[184:187], v[120:135]
  v_rcp_f32 v141, v141
  v_rcp_f32 v142, v142
  v_rcp_f32 v143, v143
  v_rcp_f32 v144, v144
  v_rcp_f32 v145, v145
  v_mfma_f32_32x32x16_bf16 v[120:135], v[52:55], a[188:191], v[120:135]
  v_rcp_f32 v146, v146
  v_rcp_f32 v147, v147
  v_rcp_f32 v148, v148
  v_rcp_f32 v149, v149
  v_rcp_f32 v150, v150
  v_rcp_f32 v151, v151
  ds_read_b128 v[18:21], v17
  v_pk_mul_f32 v[136:137], v[104:105], v[136:137]
  v_pk_mul_f32 v[138:139], v[106:107], v[138:139]
  v_pk_mul_f32 v[140:141], v[108:109], v[140:141]
  v_pk_mul_f32 v[142:143], v[110:111], v[142:143]
  v_pk_mul_f32 v[144:145], v[112:113], v[144:145]
  v_pk_mul_f32 v[146:147], v[114:115], v[146:147]
  v_pk_mul_f32 v[148:149], v[116:117], v[148:149]
  v_pk_mul_f32 v[150:151], v[118:119], v[150:151]
  v_pk_fma_f32 v[160:161], v[136:137], v[136:137], v[160:161]
  v_pk_fma_f32 v[162:163], v[138:139], v[138:139], v[162:163]
  v_pk_fma_f32 v[160:161], v[140:141], v[140:141], v[160:161]
  v_pk_fma_f32 v[162:163], v[142:143], v[142:143], v[162:163]
  v_pk_fma_f32 v[160:161], v[144:145], v[144:145], v[160:161]
  v_pk_fma_f32 v[162:163], v[146:147], v[146:147], v[162:163]
  v_pk_fma_f32 v[160:161], v[148:149], v[148:149], v[160:161]
  v_pk_fma_f32 v[162:163], v[150:151], v[150:151], v[162:163]
  v_mfma_f32_32x32x16_bf16 a[240:255], a[228:231], a[156:159], a[240:255]
  v_cvt_pk_bf16_f32 v152, v136, v137
  v_cvt_pk_bf16_f32 v153, v138, v139
  v_cvt_pk_bf16_f32 v154, v140, v141
  v_cvt_pk_bf16_f32 v155, v142, v143
  v_mfma_f32_32x32x16_bf16 a[240:255], a[232:235], a[160:163], a[240:255]
  v_cvt_pk_bf16_f32 v156, v144, v145
  v_cvt_pk_bf16_f32 v157, v146, v147
  v_cvt_pk_bf16_f32 v158, v148, v149
  v_cvt_pk_bf16_f32 v159, v150, v151
  v_mfma_f32_32x32x16_bf16 a[240:255], a[236:239], a[164:167], a[240:255]
  s_waitcnt lgkmcnt(0)
  v_min_u32 v18, v18, v19
  v_min3_u32 v18, v18, v20, v21
  v_cmp_gt_u32 vcc, 2, v18
  s_cbranch_vccz L_fw2_ok
L_fw2:
  ds_read_b128 v[18:21], v17
  s_waitcnt lgkmcnt(0)
  v_min_u32 v18, v18, v19
  v_min3_u32 v18, v18, v20, v21
  v_cmp_gt_u32 vcc, 2, v18
  s_cbranch_vccnz L_fw2
L_fw2_ok:
  ds_read_b128 v[56:59], v2 offset:33280
  ds_read_b128 v[60:63], v2 offset:33312
  ds_read_b128 v[64:67], v2 offset:33344
  ds_read_b128 v[68:71], v2 offset:33376
  ds_read_b128 v[72:75], v2 offset:33408
  ds_read_b128 v[76:79], v2 offset:33440
  ds_read_b64_tr_b16 a[48:49], v9 offset:0
  ds_read_b64_tr_b16 a[50:51], v9 offset:1024
  ds_read_b64_tr_b16 a[52:53], v9 offset:4096
  ds_read_b64_tr_b16 a[54:55], v9 offset:5120
  ds_write_b128 v4, v[152:155] offset:0
  ds_write_b128 v5, v[156:159] offset:0
  buffer_load_dwordx4 v[220:223], v23, s[44:47], s11 offen offset:0 sc1
  buffer_load_dwordx4 v[224:227], v23, s[44:47], s11 offen offset:1024 sc1
  v_accvgpr_read_b32 v244, a240
  v_accvgpr_read_b32 v245, a241
  v_pk_fma_f32 v[136:137], v[120:121], v[120:121], s[74:75]
  v_pk_fma_f32 v[138:139], v[122:123], v[122:123], s[74:75]
  v_pk_fma_f32 v[140:141], v[124:125], v[124:125], s[74:75]
  v_pk_fma_f32 v[142:143], v[126:127], v[126:127], s[74:75]
  v_pk_fma_f32 v[144:145], v[128:129], v[128:129], s[74:75]
  v_pk_fma_f32 v[146:147], v[130:131], v[130:131], s[74:75]
  v_pk_fma_f32 v[148:149], v[132:133], v[132:133], s[74:75]
  v_pk_fma_f32 v[150:151], v[134:135], v[134:135], s[74:75]
  v_pk_mul_f32 v[136:137], v[120:121], v[136:137]
  v_pk_mul_f32 v[138:139], v[122:123], v[138:139]
  v_pk_mul_f32 v[140:141], v[124:125], v[140:141]
  v_pk_mul_f32 v[142:143], v[126:127], v[142:143]
  v_pk_mul_f32 v[144:145], v[128:129], v[144:145]
  v_pk_mul_f32 v[146:147], v[130:131], v[146:147]
  v_pk_mul_f32 v[148:149], v[132:133], v[148:149]
  v_pk_mul_f32 v[150:151], v[134:135], v[150:151]
  v_mfma_f32_32x32x16_bf16 v[104:119], v[32:35], a[192:195], 0
  v_exp_f32 v136, v136
  v_exp_f32 v137, v137
  v_exp_f32 v138, v138
  v_exp_f32 v139, v139
  v_exp_f32 v140, v140
  v_mfma_f32_32x32x16_bf16 v[104:119], v[36:39], a[196:199], v[104:119]
  v_exp_f32 v141, v141
  v_exp_f32 v142, v142
  v_exp_f32 v143, v143
  v_exp_f32 v144, v144
  v_exp_f32 v145, v145
  v_mfma_f32_32x32x16_bf16 v[104:119], v[40:43], a[200:203], v[104:119]
  v_exp_f32 v146, v146
  v_exp_f32 v147, v147
  v_exp_f32 v148, v148
  v_exp_f32 v149, v149
  v_exp_f32 v150, v150
  v_exp_f32 v151, v151
  v_pk_add_f32 v[136:137], v[136:137], 1.0 op_sel_hi:[1,0]
  v_pk_add_f32 v[138:139], v[138:139], 1.0 op_sel_hi:[1,0]
  v_pk_add_f32 v[140:141], v[140:141], 1.0 op_sel_hi:[1,0]
  v_pk_add_f32 v[142:143], v[142:143], 1.0 op_sel_hi:[1,0]
  v_pk_add_f32 v[144:145], v[144:145], 1.0 op_sel_hi:[1,0]
  v_pk_add_f32 v[146:147], v[146:147], 1.0 op_sel_hi:[1,0]
  v_pk_add_f32 v[148:149], v[148:149], 1.0 op_sel_hi:[1,0]
  v_pk_add_f32 v[150:151], v[150:151], 1.0 op_sel_hi:[1,0]
  v_mfma_f32_32x32x16_bf16 v[104:119], v[44:47], a[204:207], v[104:119]
  v_rcp_f32 v136, v136
  v_rcp_f32 v137, v137
  v_rcp_f32 v138, v138
  v_rcp_f32 v139, v139
  v_rcp_f32 v140, v140
  v_mfma_f32_32x32x16_bf16 v[104:119], v[48:51], a[208:211], v[104:119]
  v_rcp_f32 v141, v141
  v_rcp_f32 v142, v142
  v_rcp_f32 v143, v143
  v_rcp_f32 v144, v144
  v_rcp_f32 v145, v145
  v_mfma_f32_32x32x16_bf16 v[104:119], v[52:55], a[212:215], v[104:119]
  v_rcp_f32 v146, v146
  v_rcp_f32 v147, v147
  v_rcp_f32 v148, v148
  v_rcp_f32 v149, v149
  v_rcp_f32 v150, v150
  v_rcp_f32 v151, v151
  v_pk_mul_f32 v[136:137], v[120:121], v[136:137]
  v_pk_mul_f32 v[138:139], v[122:123], v[138:139]
  v_pk_mul_f32 v[140:141], v[124:125], v[140:141]
  v_pk_mul_f32 v[142:143], v[126:127], v[142:143]
  v_pk_mul_f32 v[144:145], v[128:129], v[144:145]
  v_pk_mul_f32 v[146:147], v[130:131], v[146:147]
  v_pk_mul_f32 v[148:149], v[132:133], v[148:149]
  v_pk_mul_f32 v[150:151], v[134:135], v[150:151]
  v_pk_fma_f32 v[164:165], v[136:137], v[136:137], v[164:165]
  v_pk_fma_f32 v[166:167], v[138:139], v[138:139], v[166:167]
  v_pk_fma_f32 v[164:165], v[140:141], v[140:141], v[164:165]
  v_pk_fma_f32 v[166:167], v[142:143], v[142:143], v[166:167]
  v_pk_fma_f32 v[164:165], v[144:145], v[144:145], v[164:165]
  v_pk_fma_f32 v[166:167], v[146:147], v[146:147], v[166:167]
  v_pk_fma_f32 v[164:165], v[148:149], v[148:149], v[164:165]
  v_pk_fma_f32 v[166:167], v[150:151], v[150:151], v[166:167]
  v_mfma_f32_32x32x16_bf16 a[240:255], a[216:219], a[168:171], 0
  v_cvt_pk_bf16_f32 v152, v136, v137
  v_cvt_pk_bf16_f32 v153, v138, v139
  v_cvt_pk_bf16_f32 v154, v140, v141
  v_cvt_pk_bf16_f32 v155, v142, v143
  v_mfma_f32_32x32x16_bf16 a[240:255], a[220:223], a[172:175], a[240:255]
  v_cvt_pk_bf16_f32 v156, v144, v145
  v_cvt_pk_bf16_f32 v157, v146, v147
  v_cvt_pk_bf16_f32 v158, v148, v149
  v_cvt_pk_bf16_f32 v159, v150, v151
  v_mfma_f32_32x32x16_bf16 a[240:255], a[224:227], a[176:179], a[240:255]
  ds_read_b64_tr_b16 a[56:57], v9 offset:8192
  ds_read_b64_tr_b16 a[58:59], v9 offset:9216
  ds_read_b64_tr_b16 a[60:61], v9 offset:12288
  ds_read_b64_tr_b16 a[62:63], v9 offset:13312
  ds_write_b128 v4, v[152:155] offset:4096
  ds_write_b128 v5, v[156:159] offset:4096
  buffer_load_dwordx4 v[228:231], v23, s[44:47], s11 offen offset:2048 sc1
  buffer_load_dwordx4 v[232:235], v23, s[44:47], s11 offen offset:3072 sc1
  buffer_load_dwordx2 v[250:251], v28, s[56:59], 0 offen offset:128
  buffer_load_dwordx2 v[252:253], v28, s[56:59], 0 offen offset:144
  s_waitcnt lgkmcnt(12)
  v_pk_fma_f32 v[136:137], v[104:105], v[104:105], s[74:75]
  v_pk_fma_f32 v[138:139], v[106:107], v[106:107], s[74:75]
  v_pk_fma_f32 v[140:141], v[108:109], v[108:109], s[74:75]
  v_pk_fma_f32 v[142:143], v[110:111], v[110:111], s[74:75]
  v_pk_fma_f32 v[144:145], v[112:113], v[112:113], s[74:75]
  v_pk_fma_f32 v[146:147], v[114:115], v[114:115], s[74:75]
  v_pk_fma_f32 v[148:149], v[116:117], v[116:117], s[74:75]
  v_pk_fma_f32 v[150:151], v[118:119], v[118:119], s[74:75]
  v_pk_mul_f32 v[136:137], v[104:105], v[136:137]
  v_pk_mul_f32 v[138:139], v[106:107], v[138:139]
  v_pk_mul_f32 v[140:141], v[108:109], v[140:141]
  v_pk_mul_f32 v[142:143], v[110:111], v[142:143]
  v_pk_mul_f32 v[144:145], v[112:113], v[144:145]
  v_pk_mul_f32 v[146:147], v[114:115], v[146:147]
  v_pk_mul_f32 v[148:149], v[116:117], v[148:149]
  v_pk_mul_f32 v[150:151], v[118:119], v[150:151]
  v_mfma_f32_32x32x16_bf16 v[120:135], v[56:59], a[144:147], 0
  v_exp_f32 v136, v136
  v_exp_f32 v137, v137
  v_exp_f32 v138, v138
  v_exp_f32 v139, v139
  v_exp_f32 v140, v140
  v_mfma_f32_32x32x16_bf16 v[120:135], v[60:63], a[148:151], v[120:135]
  v_exp_f32 v141, v141
  v_exp_f32 v142, v142
  v_exp_f32 v143, v143
  v_exp_f32 v144, v144
  v_exp_f32 v145, v145
  v_mfma_f32_32x32x16_bf16 v[120:135], v[64:67], a[152:155], v[120:135]
  v_exp_f32 v146, v146
  v_exp_f32 v147, v147
  v_exp_f32 v148, v148
  v_exp_f32 v149, v149
  v_exp_f32 v150, v150
  v_exp_f32 v151, v151
  v_pk_add_f32 v[136:137], v[136:137], 1.0 op_sel_hi:[1,0]
  v_pk_add_f32 v[138:139], v[138:139], 1.0 op_sel_hi:[1,0]
  v_pk_add_f32 v[140:141], v[140:141], 1.0 op_sel_hi:[1,0]
  v_pk_add_f32 v[142:143], v[142:143], 1.0 op_sel_hi:[1,0]
  v_pk_add_f32 v[144:145], v[144:145], 1.0 op_sel_hi:[1,0]
  v_pk_add_f32 v[146:147], v[146:147], 1.0 op_sel_hi:[1,0]
  v_pk_add_f32 v[148:149], v[148:149], 1.0 op_sel_hi:[1,0]
  v_pk_add_f32 v[150:151], v[150:151], 1.0 op_sel_hi:[1,0]
  v_mfma_f32_32x32x16_bf16 v[120:135], v[68:71], a[156:159], v[120:135]
  v_rcp_f32 v136, v136
  v_rcp_f32 v137, v137
  v_rcp_f32 v138, v138
  v_rcp_f32 v139, v139
  v_rcp_f32 v140, v140
  v_mfma_f32_32x32x16_bf16 v[120:135], v[72:75], a[160:163], v[120:135]
  v_rcp_f32 v141, v141
  v_rcp_f32 v142, v142
  v_rcp_f32 v143, v143
  v_rcp_f32 v144, v144
  v_rcp_f32 v145, v145
  v_mfma_f32_32x32x16_bf16 v[120:135], v[76:79], a[164:167], v[120:135]
  v_rcp_f32 v146, v146
  v_rcp_f32 v147, v147
  v_rcp_f32 v148, v148
  v_rcp_f32 v149, v149
  v_rcp_f32 v150, v150
  v_rcp_f32 v151, v151
  v_pk_mul_f32 v[136:137], v[104:105], v[136:137]
  v_pk_mul_f32 v[138:139], v[106:107], v[138:139]
  v_pk_mul_f32 v[140:141], v[108:109], v[140:141]
  v_pk_mul_f32 v[142:143], v[110:111], v[142:143]
  v_pk_mul_f32 v[144:145], v[112:113], v[144:145]
  v_pk_mul_f32 v[146:147], v[114:115], v[146:147]
  v_pk_mul_f32 v[148:149], v[116:117], v[148:149]
  v_pk_mul_f32 v[150:151], v[118:119], v[150:151]
  v_pk_fma_f32 v[168:169], v[136:137], v[136:137], v[168:169]
  v_pk_fma_f32 v[170:171], v[138:139], v[138:139], v[170:171]
  v_pk_fma_f32 v[168:169], v[140:141], v[140:141], v[168:169]
  v_pk_fma_f32 v[170:171], v[142:143], v[142:143], v[170:171]
  v_pk_fma_f32 v[168:169], v[144:145], v[144:145], v[168:169]
  v_pk_fma_f32 v[170:171], v[146:147], v[146:147], v[170:171]
  v_pk_fma_f32 v[168:169], v[148:149], v[148:149], v[168:169]
  v_pk_fma_f32 v[170:171], v[150:151], v[150:151], v[170:171]
  v_mfma_f32_32x32x16_bf16 a[240:255], a[228:231], a[180:183], a[240:255]
  v_cvt_pk_bf16_f32 v152, v136, v137
  v_cvt_pk_bf16_f32 v153, v138, v139
  v_cvt_pk_bf16_f32 v154, v140, v141
  v_cvt_pk_bf16_f32 v155, v142, v143
  v_mfma_f32_32x32x16_bf16 a[240:255], a[232:235], a[184:187], a[240:255]
  v_cvt_pk_bf16_f32 v156, v144, v145
  v_cvt_pk_bf16_f32 v157, v146, v147
  v_cvt_pk_bf16_f32 v158, v148, v149
  v_cvt_pk_bf16_f32 v159, v150, v151
  v_mfma_f32_32x32x16_bf16 a[240:255], a[236:239], a[188:191], a[240:255]
  ds_read_b64_tr_b16 a[64:65], v9 offset:16384
  ds_read_b64_tr_b16 a[66:67], v9 offset:17408
  ds_read_b64_tr_b16 a[68:69], v9 offset:20480
  ds_read_b64_tr_b16 a[70:71], v9 offset:21504
  ds_write_b128 v4, v[152:155] offset:8192
  ds_write_b128 v5, v[156:159] offset:8192
  buffer_load_dwordx4 v[236:239], v23, s[44:47], s13 offen offset:0 sc1
  buffer_load_dwordx4 v[240:243], v23, s[44:47], s13 offen offset:1024 sc1
  s_nop 3
  v_accvgpr_read_b32 v246, a240
  v_accvgpr_read_b32 v247, a241
  v_pk_fma_f32 v[136:137], v[120:121], v[120:121], s[74:75]
  v_pk_fma_f32 v[138:139], v[122:123], v[122:123], s[74:75]
  v_pk_fma_f32 v[140:141], v[124:125], v[124:125], s[74:75]
  v_pk_fma_f32 v[142:143], v[126:127], v[126:127], s[74:75]
  v_pk_fma_f32 v[144:145], v[128:129], v[128:129], s[74:75]
  v_pk_fma_f32 v[146:147], v[130:131], v[130:131], s[74:75]
  v_pk_fma_f32 v[148:149], v[132:133], v[132:133], s[74:75]
  v_pk_fma_f32 v[150:151], v[134:135], v[134:135], s[74:75]
  v_pk_mul_f32 v[136:137], v[120:121], v[136:137]
  v_pk_mul_f32 v[138:139], v[122:123], v[138:139]
  v_pk_mul_f32 v[140:141], v[124:125], v[140:141]
  v_pk_mul_f32 v[142:143], v[126:127], v[142:143]
  v_pk_mul_f32 v[144:145], v[128:129], v[144:145]
  v_pk_mul_f32 v[146:147], v[130:131], v[146:147]
  v_pk_mul_f32 v[148:149], v[132:133], v[148:149]
  v_pk_mul_f32 v[150:151], v[134:135], v[150:151]
  v_mfma_f32_32x32x16_bf16 v[104:119], v[56:59], a[168:171], 0
  v_exp_f32 v136, v136
  v_exp_f32 v137, v137
  v_exp_f32 v138, v138
  v_exp_f32 v139, v139
  v_exp_f32 v140, v140
  v_mfma_f32_32x32x16_bf16 v[104:119], v[60:63], a[172:175], v[104:119]
  v_exp_f32 v141, v141
  v_exp_f32 v142, v142
  v_exp_f32 v143, v143
  v_exp_f32 v144, v144
  v_exp_f32 v145, v145
  v_mfma_f32_32x32x16_bf16 v[104:119], v[64:67], a[176:179], v[104:119]
  v_exp_f32 v146, v146
  v_exp_f32 v147, v147
  v_exp_f32 v148, v148
  v_exp_f32 v149, v149
  v_exp_f32 v150, v150
  v_exp_f32 v151, v151
  v_pk_add_f32 v[136:137], v[136:137], 1.0 op_sel_hi:[1,0]
  v_pk_add_f32 v[138:139], v[138:139], 1.0 op_sel_hi:[1,0]
  v_pk_add_f32 v[140:141], v[140:141], 1.0 op_sel_hi:[1,0]
  v_pk_add_f32 v[142:143], v[142:143], 1.0 op_sel_hi:[1,0]
  v_pk_add_f32 v[144:145], v[144:145], 1.0 op_sel_hi:[1,0]
  v_pk_add_f32 v[146:147], v[146:147], 1.0 op_sel_hi:[1,0]
  v_pk_add_f32 v[148:149], v[148:149], 1.0 op_sel_hi:[1,0]
  v_pk_add_f32 v[150:151], v[150:151], 1.0 op_sel_hi:[1,0]
  v_mfma_f32_32x32x16_bf16 v[104:119], v[68:71], a[180:183], v[104:119]
  v_rcp_f32 v136, v136
  v_rcp_f32 v137, v137
  v_rcp_f32 v138, v138
  v_rcp_f32 v139, v139
  v_rcp_f32 v140, v140
  v_mfma_f32_32x32x16_bf16 v[104:119], v[72:75], a[184:187], v[104:119]
  v_rcp_f32 v141, v141
  v_rcp_f32 v142, v142
  v_rcp_f32 v143, v143
  v_rcp_f32 v144, v144
  v_rcp_f32 v145, v145
  v_mfma_f32_32x32x16_bf16 v[104:119], v[76:79], a[188:191], v[104:119]
  v_rcp_f32 v146, v146
  v_rcp_f32 v147, v147
  v_rcp_f32 v148, v148
  v_rcp_f32 v149, v149
  v_rcp_f32 v150, v150
  v_rcp_f32 v151, v151
  v_pk_mul_f32 v[136:137], v[120:121], v[136:137]
  v_pk_mul_f32 v[138:139], v[122:123], v[138:139]
  v_pk_mul_f32 v[140:141], v[124:125], v[140:141]
  v_pk_mul_f32 v[142:143], v[126:127], v[142:143]
  v_pk_mul_f32 v[144:145], v[128:129], v[144:145]
  v_pk_mul_f32 v[146:147], v[130:131], v[146:147]
  v_pk_mul_f32 v[148:149], v[132:133], v[148:149]
  v_pk_mul_f32 v[150:151], v[134:135], v[150:151]
  v_pk_fma_f32 v[160:161], v[136:137], v[136:137], v[160:161]
  v_pk_fma_f32 v[162:163], v[138:139], v[138:139], v[162:163]
  v_pk_fma_f32 v[160:161], v[140:141], v[140:141], v[160:161]
  v_pk_fma_f32 v[162:163], v[142:143], v[142:143], v[162:163]
  v_pk_fma_f32 v[160:161], v[144:145], v[144:145], v[160:161]
  v_pk_fma_f32 v[162:163], v[146:147], v[146:147], v[162:163]
  v_pk_fma_f32 v[160:161], v[148:149], v[148:149], v[160:161]
  v_pk_fma_f32 v[162:163], v[150:151], v[150:151], v[162:163]
  v_mfma_f32_32x32x16_bf16 a[240:255], a[216:219], a[192:195], 0
  v_cvt_pk_bf16_f32 v152, v136, v137
  v_cvt_pk_bf16_f32 v153, v138, v139
  v_cvt_pk_bf16_f32 v154, v140, v141
  v_cvt_pk_bf16_f32 v155, v142, v143
  v_mfma_f32_32x32x16_bf16 a[240:255], a[220:223], a[196:199], a[240:255]
  v_cvt_pk_bf16_f32 v156, v144, v145
  v_cvt_pk_bf16_f32 v157, v146, v147
  v_cvt_pk_bf16_f32 v158, v148, v149
  v_cvt_pk_bf16_f32 v159, v150, v151
  v_mfma_f32_32x32x16_bf16 a[240:255], a[224:227], a[200:203], a[240:255]
  ds_read_b64_tr_b16 a[72:73], v9 offset:24576
  ds_read_b64_tr_b16 a[74:75], v9 offset:25600
  ds_read_b64_tr_b16 a[76:77], v9 offset:28672
  ds_read_b64_tr_b16 a[78:79], v9 offset:29696
  ds_write_b128 v6, v[152:155] offset:0
  ds_write_b128 v7, v[156:159] offset:0
  v_pk_fma_f32 v[136:137], v[104:105], v[104:105], s[74:75]
  v_pk_fma_f32 v[138:139], v[106:107], v[106:107], s[74:75]
  v_pk_fma_f32 v[140:141], v[108:109], v[108:109], s[74:75]
  v_pk_fma_f32 v[142:143], v[110:111], v[110:111], s[74:75]
  v_pk_fma_f32 v[144:145], v[112:113], v[112:113], s[74:75]
  v_pk_fma_f32 v[146:147], v[114:115], v[114:115], s[74:75]
  v_pk_fma_f32 v[148:149], v[116:117], v[116:117], s[74:75]
  v_pk_fma_f32 v[150:151], v[118:119], v[118:119], s[74:75]
  v_pk_mul_f32 v[136:137], v[104:105], v[136:137]
  v_pk_mul_f32 v[138:139], v[106:107], v[138:139]
  v_pk_mul_f32 v[140:141], v[108:109], v[140:141]
  v_pk_mul_f32 v[142:143], v[110:111], v[142:143]
  v_pk_mul_f32 v[144:145], v[112:113], v[144:145]
  v_pk_mul_f32 v[146:147], v[114:115], v[146:147]
  v_pk_mul_f32 v[148:149], v[116:117], v[148:149]
  v_pk_mul_f32 v[150:151], v[118:119], v[150:151]
  v_mfma_f32_32x32x16_bf16 v[120:135], v[56:59], a[192:195], 0
  v_exp_f32 v136, v136
  v_exp_f32 v137, v137
  v_exp_f32 v138, v138
  v_exp_f32 v139, v139
  v_exp_f32 v140, v140
  v_mfma_f32_32x32x16_bf16 v[120:135], v[60:63], a[196:199], v[120:135]
  v_exp_f32 v141, v141
  v_exp_f32 v142, v142
  v_exp_f32 v143, v143
  v_exp_f32 v144, v144
  v_exp_f32 v145, v145
  v_mfma_f32_32x32x16_bf16 v[120:135], v[64:67], a[200:203], v[120:135]
  v_exp_f32 v146, v146
  v_exp_f32 v147, v147
  v_exp_f32 v148, v148
  v_exp_f32 v149, v149
  v_exp_f32 v150, v150
  v_exp_f32 v151, v151
  v_pk_add_f32 v[136:137], v[136:137], 1.0 op_sel_hi:[1,0]
  v_pk_add_f32 v[138:139], v[138:139], 1.0 op_sel_hi:[1,0]
  v_pk_add_f32 v[140:141], v[140:141], 1.0 op_sel_hi:[1,0]
  v_pk_add_f32 v[142:143], v[142:143], 1.0 op_sel_hi:[1,0]
  v_pk_add_f32 v[144:145], v[144:145], 1.0 op_sel_hi:[1,0]
  v_pk_add_f32 v[146:147], v[146:147], 1.0 op_sel_hi:[1,0]
  v_pk_add_f32 v[148:149], v[148:149], 1.0 op_sel_hi:[1,0]
  v_pk_add_f32 v[150:151], v[150:151], 1.0 op_sel_hi:[1,0]
  v_mfma_f32_32x32x16_bf16 v[120:135], v[68:71], a[204:207], v[120:135]
  v_rcp_f32 v136, v136
  v_rcp_f32 v137, v137
  v_rcp_f32 v138, v138
  v_rcp_f32 v139, v139
  v_rcp_f32 v140, v140
  v_mfma_f32_32x32x16_bf16 v[120:135], v[72:75], a[208:211], v[120:135]
  v_rcp_f32 v141, v141
  v_rcp_f32 v142, v142
  v_rcp_f32 v143, v143
  v_rcp_f32 v144, v144
  v_rcp_f32 v145, v145
  v_mfma_f32_32x32x16_bf16 v[120:135], v[76:79], a[212:215], v[120:135]
  v_rcp_f32 v146, v146
  v_rcp_f32 v147, v147
  v_rcp_f32 v148, v148
  v_rcp_f32 v149, v149
  v_rcp_f32 v150, v150
  v_rcp_f32 v151, v151
  v_pk_mul_f32 v[136:137], v[104:105], v[136:137]
  v_pk_mul_f32 v[138:139], v[106:107], v[138:139]
  v_pk_mul_f32 v[140:141], v[108:109], v[140:141]
  v_pk_mul_f32 v[142:143], v[110:111], v[142:143]
  v_pk_mul_f32 v[144:145], v[112:113], v[144:145]
  v_pk_mul_f32 v[146:147], v[114:115], v[146:147]
  v_pk_mul_f32 v[148:149], v[116:117], v[148:149]
  v_pk_mul_f32 v[150:151], v[118:119], v[150:151]
  v_pk_fma_f32 v[164:165], v[136:137], v[136:137], v[164:165]
  v_pk_fma_f32 v[166:167], v[138:139], v[138:139], v[166:167]
  v_pk_fma_f32 v[164:165], v[140:141], v[140:141], v[164:165]
  v_pk_fma_f32 v[166:167], v[142:143], v[142:143], v[166:167]
  v_pk_fma_f32 v[164:165], v[144:145], v[144:145], v[164:165]
  v_pk_fma_f32 v[166:167], v[146:147], v[146:147], v[166:167]
  v_pk_fma_f32 v[164:165], v[148:149], v[148:149], v[164:165]
  v_pk_fma_f32 v[166:167], v[150:151], v[150:151], v[166:167]
  v_mfma_f32_32x32x16_bf16 a[240:255], a[228:231], a[204:207], a[240:255]
  v_cvt_pk_bf16_f32 v152, v136, v137
  v_cvt_pk_bf16_f32 v153, v138, v139
  v_cvt_pk_bf16_f32 v154, v140, v141
  v_cvt_pk_bf16_f32 v155, v142, v143
  v_mfma_f32_32x32x16_bf16 a[240:255], a[232:235], a[208:211], a[240:255]
  v_cvt_pk_bf16_f32 v156, v144, v145
  v_cvt_pk_bf16_f32 v157, v146, v147
  v_cvt_pk_bf16_f32 v158, v148, v149
  v_cvt_pk_bf16_f32 v159, v150, v151
  v_mfma_f32_32x32x16_bf16 a[240:255], a[236:239], a[212:215], a[240:255]
  ds_read_b64_tr_b16 a[80:81], v9 offset:32768
  ds_read_b64_tr_b16 a[82:83], v9 offset:33792
  ds_read_b64_tr_b16 a[84:85], v9 offset:36864
  ds_read_b64_tr_b16 a[86:87], v9 offset:37888
  ds_write_b128 v6, v[152:155] offset:4096
  ds_write_b128 v7, v[156:159] offset:4096
  buffer_load_dword v30, v31, s[48:51], 0 offen sc1
  s_nop 4
  v_accvgpr_read_b32 v248, a240
  v_accvgpr_read_b32 v249, a241
  v_pk_fma_f32 v[136:137], v[120:121], v[120:121], s[74:75]
  v_pk_fma_f32 v[138:139], v[122:123], v[122:123], s[74:75]
  v_pk_fma_f32 v[140:141], v[124:125], v[124:125], s[74:75]
  v_pk_fma_f32 v[142:143], v[126:127], v[126:127], s[74:75]
  v_pk_fma_f32 v[144:145], v[128:129], v[128:129], s[74:75]
  v_pk_fma_f32 v[146:147], v[130:131], v[130:131], s[74:75]
  v_pk_fma_f32 v[148:149], v[132:133], v[132:133], s[74:75]
  v_pk_fma_f32 v[150:151], v[134:135], v[134:135], s[74:75]
  v_pk_mul_f32 v[136:137], v[120:121], v[136:137]
  v_pk_mul_f32 v[138:139], v[122:123], v[138:139]
  v_pk_mul_f32 v[140:141], v[124:125], v[140:141]
  v_pk_mul_f32 v[142:143], v[126:127], v[142:143]
  v_pk_mul_f32 v[144:145], v[128:129], v[144:145]
  v_pk_mul_f32 v[146:147], v[130:131], v[146:147]
  v_pk_mul_f32 v[148:149], v[132:133], v[148:149]
  v_pk_mul_f32 v[150:151], v[134:135], v[150:151]
  v_exp_f32 v136, v136
  v_exp_f32 v137, v137
  v_exp_f32 v138, v138
  v_exp_f32 v139, v139
  v_exp_f32 v140, v140
  v_exp_f32 v141, v141
  v_exp_f32 v142, v142
  v_exp_f32 v143, v143
  v_exp_f32 v144, v144
  v_exp_f32 v145, v145
  v_exp_f32 v146, v146
  v_exp_f32 v147, v147
  v_exp_f32 v148, v148
  v_exp_f32 v149, v149
  v_exp_f32 v150, v150
  v_exp_f32 v151, v151
  v_pk_add_f32 v[136:137], v[136:137], 1.0 op_sel_hi:[1,0]
  v_pk_add_f32 v[138:139], v[138:139], 1.0 op_sel_hi:[1,0]
  v_pk_add_f32 v[140:141], v[140:141], 1.0 op_sel_hi:[1,0]
  v_pk_add_f32 v[142:143], v[142:143], 1.0 op_sel_hi:[1,0]
  v_pk_add_f32 v[144:145], v[144:145], 1.0 op_sel_hi:[1,0]
  v_pk_add_f32 v[146:147], v[146:147], 1.0 op_sel_hi:[1,0]
  v_pk_add_f32 v[148:149], v[148:149], 1.0 op_sel_hi:[1,0]
  v_pk_add_f32 v[150:151], v[150:151], 1.0 op_sel_hi:[1,0]
  v_rcp_f32 v136, v136
  v_rcp_f32 v137, v137
  v_rcp_f32 v138, v138
  v_rcp_f32 v139, v139
  v_rcp_f32 v140, v140
  v_rcp_f32 v141, v141
  v_rcp_f32 v142, v142
  v_rcp_f32 v143, v143
  v_rcp_f32 v144, v144
  v_rcp_f32 v145, v145
  v_rcp_f32 v146, v146
  v_rcp_f32 v147, v147
  v_rcp_f32 v148, v148
  v_rcp_f32 v149, v149
  v_rcp_f32 v150, v150
  v_rcp_f32 v151, v151
  v_pk_mul_f32 v[136:137], v[120:121], v[136:137]
  v_pk_mul_f32 v[138:139], v[122:123], v[138:139]
  v_pk_mul_f32 v[140:141], v[124:125], v[140:141]
  v_pk_mul_f32 v[142:143], v[126:127], v[142:143]
  v_pk_mul_f32 v[144:145], v[128:129], v[144:145]
  v_pk_mul_f32 v[146:147], v[130:131], v[146:147]
  v_pk_mul_f32 v[148:149], v[132:133], v[148:149]
  v_pk_mul_f32 v[150:151], v[134:135], v[150:151]
  v_pk_fma_f32 v[168:169], v[136:137], v[136:137], v[168:169]
  v_pk_fma_f32 v[170:171], v[138:139], v[138:139], v[170:171]
  v_pk_fma_f32 v[168:169], v[140:141], v[140:141], v[168:169]
  v_pk_fma_f32 v[170:171], v[142:143], v[142:143], v[170:171]
  v_pk_fma_f32 v[168:169], v[144:145], v[144:145], v[168:169]
  v_pk_fma_f32 v[170:171], v[146:147], v[146:147], v[170:171]
  v_pk_fma_f32 v[168:169], v[148:149], v[148:149], v[168:169]
  v_pk_fma_f32 v[170:171], v[150:151], v[150:151], v[170:171]
  v_pk_fma_f32 v[18:19], v[244:245], v[244:245], s[74:75]
  v_pk_fma_f32 v[20:21], v[246:247], v[246:247], s[74:75]
  v_pk_fma_f32 v[254:255], v[248:249], v[248:249], s[74:75]
  v_pk_mul_f32 v[18:19], v[244:245], v[18:19]
  v_pk_mul_f32 v[20:21], v[246:247], v[20:21]
  v_pk_mul_f32 v[254:255], v[248:249], v[254:255]
  v_exp_f32 v18, v18
  v_exp_f32 v19, v19
  v_exp_f32 v20, v20
  v_exp_f32 v21, v21
  v_exp_f32 v254, v254
  v_exp_f32 v255, v255
  v_pk_add_f32 v[18:19], v[18:19], 1.0 op_sel_hi:[1,0]
  v_pk_add_f32 v[20:21], v[20:21], 1.0 op_sel_hi:[1,0]
  v_pk_add_f32 v[254:255], v[254:255], 1.0 op_sel_hi:[1,0]
  v_rcp_f32 v18, v18
  v_rcp_f32 v19, v19
  v_rcp_f32 v20, v20
  v_rcp_f32 v21, v21
  v_rcp_f32 v254, v254
  v_rcp_f32 v255, v255
  v_pk_mul_f32 v[18:19], v[244:245], v[18:19]
  v_pk_mul_f32 v[20:21], v[246:247], v[20:21]
  v_pk_mul_f32 v[254:255], v[248:249], v[254:255]
  v_pk_fma_f32 v[160:161], v[18:19], v[18:19], v[160:161]
  v_pk_fma_f32 v[164:165], v[20:21], v[20:21], v[164:165]
  v_pk_fma_f32 v[168:169], v[254:255], v[254:255], v[168:169]
  v_pk_add_f32 v[160:161], v[160:161], v[162:163]
  v_add_f32 v160, v160, v161
  v_pk_add_f32 v[164:165], v[164:165], v[166:167]
  v_add_f32 v164, v164, v165
  v_pk_add_f32 v[168:169], v[168:169], v[170:171]
  v_add_f32 v168, v168, v169
  v_mov_b32 v169, v168
  v_permlane32_swap_b32 v160, v164
  s_nop 0
  v_permlane32_swap_b32 v168, v169
  v_add_f32 v160, v160, v164
  v_add_f32 v168, v168, v169
  v_and_b32 v152, 0x7fffffff, v160
  v_and_b32 v156, 0x7fffffff, v168
  s_mul_i32 s62, s2, 1536
  s_mul_i32 s63, s22, 384
  s_add_u32 s62, s62, s63
  v_lshlrev_b32 v16, 2, v1
  v_add_u32 v16, s62, v16
  v_mov_b32_dpp v153, v152 quad_perm:[1,1,1,1] row_mask:0xf bank_mask:0xf
  v_mov_b32_dpp v154, v152 quad_perm:[2,2,2,2] row_mask:0xf bank_mask:0xf
  v_mov_b32_dpp v155, v152 quad_perm:[3,3,3,3] row_mask:0xf bank_mask:0xf
  v_mov_b32_dpp v157, v156 quad_perm:[1,1,1,1] row_mask:0xf bank_mask:0xf
  v_mov_b32_dpp v158, v156 quad_perm:[2,2,2,2] row_mask:0xf bank_mask:0xf
  v_mov_b32_dpp v159, v156 quad_perm:[3,3,3,3] row_mask:0xf bank_mask:0xf
  s_waitcnt vmcnt(0)
  v_cmp_gt_u32 vcc, 64, v30
  s_cbranch_vccz L_chk_done
  s_mov_b32 s78, 400000
L_chk:
  buffer_load_dword v30, v31, s[48:51], 0 offen sc1
  s_waitcnt vmcnt(0)
  v_cmp_gt_u32 vcc, 64, v30
  s_cbranch_vccz L_chk_done
  s_sleep 1
  s_sub_u32 s78, s78, 1
  s_cmp_lg_u32 s78, 0
  s_cbranch_scc1 L_chk
L_chk_done:
  s_mov_b32 exec_lo, 0x11111111
  s_mov_b32 exec_hi, 0x11111111
  buffer_store_dwordx4 v[152:155], v16, s[44:47], 0 offen sc1
  s_mov_b32 exec_hi, 0
  buffer_store_dwordx4 v[156:159], v16, s[44:47], 0 offen offset:256 sc1
  s_mov_b64 exec, -1
  v_cvt_pk_bf16_f32 v152, v136, v137
  v_mfma_f32_16x16x32_bf16 v[80:83], v[220:223], v[250:253], v[80:83]
  v_cvt_pk_bf16_f32 v153, v138, v139
  v_mfma_f32_16x16x32_bf16 v[84:87], v[224:227], v[250:253], v[84:87]
  v_cvt_pk_bf16_f32 v154, v140, v141
  v_mfma_f32_16x16x32_bf16 v[88:91], v[228:231], v[250:253], v[88:91]
  v_cvt_pk_bf16_f32 v155, v142, v143
  v_mfma_f32_16x16x32_bf16 v[92:95], v[232:235], v[250:253], v[92:95]
  v_cvt_pk_bf16_f32 v156, v144, v145
  v_cvt_pk_bf16_f32 v157, v146, v147
  v_cvt_pk_bf16_f32 v158, v148, v149
  v_cvt_pk_bf16_f32 v159, v150, v151
  v_mfma_f32_16x16x32_bf16 v[96:99], v[236:239], v[250:253], v[96:99]
  v_mfma_f32_16x16x32_bf16 v[100:103], v[240:243], v[250:253], v[100:103]
  ds_read_b64_tr_b16 a[88:89], v9 offset:40960
  ds_read_b64_tr_b16 a[90:91], v9 offset:41984
  ds_read_b64_tr_b16 a[92:93], v9 offset:45056
  ds_read_b64_tr_b16 a[94:95], v9 offset:46080
  ds_write_b128 v6, v[152:155] offset:8192
  ds_write_b128 v7, v[156:159] offset:8192
  v_cvt_pk_bf16_f32 v18, v18, v19
  v_cvt_pk_bf16_f32 v20, v20, v21
  v_cvt_pk_bf16_f32 v254, v254, v255
  ds_write_b32 v10, v18 offset:0
  ds_write_b32 v10, v20 offset:256
  ds_write_b32 v10, v254 offset:512
  s_mul_i32 s62, s22, 384
  s_add_u32 s62, s62, 4096
  v_add_u32 v156, s62, v26
  s_mov_b32 exec_lo, 0x00010001
  s_mov_b32 exec_hi, 0x00010001
  ds_write_b128 v156, v[80:83] offset:0
  ds_write_b128 v156, v[84:87] offset:16
  ds_write_b128 v156, v[88:91] offset:128
  ds_write_b128 v156, v[92:95] offset:144
  ds_write_b128 v156, v[96:99] offset:256
  ds_write_b128 v156, v[100:103] offset:272
  s_mov_b64 exec, -1
  s_waitcnt lgkmcnt(0)
  s_barrier
  buffer_load_dwordx4 a[192:195], v12, s[24:27], 0 offen offset:0
  buffer_load_dwordx4 a[196:199], v12, s[24:27], 0 offen offset:64
  buffer_load_dwordx4 a[200:203], v12, s[24:27], 0 offen offset:128
  buffer_load_dwordx4 a[204:207], v13, s[24:27], 0 offen offset:0
  buffer_load_dwordx4 a[208:211], v13, s[24:27], 0 offen offset:64
  buffer_load_dwordx4 a[212:215], v13, s[24:27], 0 offen offset:128
  buffer_load_dwordx4 a[216:219], v14, s[24:27], 0 offen offset:0
  buffer_load_dwordx4 a[220:223], v14, s[24:27], 0 offen offset:64
  buffer_load_dwordx4 a[224:227], v14, s[24:27], 0 offen offset:128
  buffer_load_dwordx4 a[228:231], v15, s[24:27], 0 offen
  v_lshlrev_b32 v6, 3, v1
  buffer_load_dwordx2 v[2:3], v6, s[52:55], 0 offen
  buffer_load_dwordx2 v[4:5], v6, s[52:55], 0 offen offset:512
  s_lshr_b32 s96, s2, 3
  s_lshl_b32 s96, s96, 2
  s_and_b32 s63, s2, 3
  s_add_u32 s96, s96, s63
  s_bitcmp1_b32 s2, 2
  s_cselect_b32 s96, 1023, s96
  s_cmp_ge_u32 s96, 24
  s_cbranch_scc1 L_nored
  v_lshrrev_b32 v56, 2, v1
  v_mul_u32_u24 v56, 1536, v56
  v_and_b32 v57, 3, v1
  v_lshlrev_b32 v57, 4, v57
  s_lshl_b32 s63, s96, 6
  v_add3_u32 v56, v56, v57, s63
  v_add_u32 v57, 524288, v56
  s_mul_i32 s62, s22, 98304
  v_add_u32 v56, s62, v56
  s_lshl_b32 s62, s22, 10
  s_add_u32 s62, s62, 8192
  v_add_u32 v60, s62, v23
  v_add_u32 v61, 8192, v23
  s_mov_b32 s64, 24576
  s_mov_b32 s65, 49152
  s_mov_b32 s66, 73728
  s_mov_b32 s78, 400000
L_red:
  buffer_load_dwordx4 v[32:35], v56, s[44:47], 0 offen sc1
  buffer_load_dwordx4 v[36:39], v56, s[44:47], s64 offen sc1
  buffer_load_dwordx4 v[40:43], v56, s[44:47], s65 offen sc1
  buffer_load_dwordx4 v[44:47], v56, s[44:47], s66 offen sc1
  s_waitcnt vmcnt(0)
  v_max3_u32 v58, v32, v33, v34
  v_max3_u32 v59, v35, v36, v37
  v_max3_u32 v58, v58, v38, v39
  v_max3_u32 v59, v59, v40, v41
  v_max3_u32 v58, v58, v42, v43
  v_max3_u32 v59, v59, v44, v45
  v_max3_u32 v58, v58, v46, v47
  v_max_u32 v58, v58, v59
  v_cmp_eq_u32 vcc, -1, v58
  s_cbranch_vccz L_red_got
  s_sub_u32 s78, s78, 1
  s_cmp_lg_u32 s78, 0
  s_cbranch_scc1 L_red
L_red_got:
  v_pk_add_f32 v[32:33], v[32:33], v[40:41]
  v_pk_add_f32 v[34:35], v[34:35], v[42:43]
  v_pk_add_f32 v[36:37], v[36:37], v[44:45]
  v_pk_add_f32 v[38:39], v[38:39], v[46:47]
  v_pk_add_f32 v[32:33], v[32:33], v[36:37]
  v_pk_add_f32 v[34:35], v[34:35], v[38:39]
  ds_write_b128 v60, v[32:35]
  s_waitcnt lgkmcnt(0)
  s_barrier
  s_cmp_lg_u32 s22, 3
  s_cbranch_scc1 L_nored
  ds_read_b128 v[32:35], v61 offset:0
  ds_read_b128 v[36:39], v61 offset:1024
  ds_read_b128 v[40:43], v61 offset:2048
  ds_read_b128 v[44:47], v61 offset:3072
  s_waitcnt lgkmcnt(0)
  v_pk_add_f32 v[32:33], v[32:33], v[40:41]
  v_pk_add_f32 v[34:35], v[34:35], v[42:43]
  v_pk_add_f32 v[36:37], v[36:37], v[44:45]
  v_pk_add_f32 v[38:39], v[38:39], v[46:47]
  v_pk_add_f32 v[32:33], v[32:33], v[36:37]
  v_pk_add_f32 v[34:35], v[34:35], v[38:39]
  s_nop 0
  v_add_f32_dpp v32, v32, v32 row_ror:4 row_mask:0xf bank_mask:0xf
  v_add_f32_dpp v33, v33, v33 row_ror:4 row_mask:0xf bank_mask:0xf
  v_add_f32_dpp v34, v34, v34 row_ror:4 row_mask:0xf bank_mask:0xf
  v_add_f32_dpp v35, v35, v35 row_ror:4 row_mask:0xf bank_mask:0xf
  v_add_f32_dpp v32, v32, v32 row_ror:8 row_mask:0xf bank_mask:0xf
  v_add_f32_dpp v33, v33, v33 row_ror:8 row_mask:0xf bank_mask:0xf
  v_add_f32_dpp v34, v34, v34 row_ror:8 row_mask:0xf bank_mask:0xf
  v_add_f32_dpp v35, v35, v35 row_ror:8 row_mask:0xf bank_mask:0xf
  v_mov_b32 v36, v32
  v_mov_b32 v37, v33
  v_mov_b32 v38, v34
  v_mov_b32 v39, v35
  v_permlane16_swap_b32 v36, v32
  v_permlane16_swap_b32 v37, v33
  v_permlane16_swap_b32 v38, v34
  v_permlane16_swap_b32 v39, v35
  v_add_f32 v32, v32, v36
  v_add_f32 v33, v33, v37
  v_add_f32 v34, v34, v38
  v_add_f32 v35, v35, v39
  v_mov_b32 v36, v32
  v_mov_b32 v37, v33
  v_mov_b32 v38, v34
  v_mov_b32 v39, v35
  v_permlane32_swap_b32 v36, v32
  v_permlane32_swap_b32 v37, v33
  v_permlane32_swap_b32 v38, v34
  v_permlane32_swap_b32 v39, v35
  v_add_f32 v32, v32, v36
  v_add_f32 v33, v33, v37
  v_add_f32 v34, v34, v38
  v_add_f32 v35, v35, v39
  v_and_b32 v32, 0x7fffffff, v32
  v_and_b32 v33, 0x7fffffff, v33
  v_and_b32 v34, 0x7fffffff, v34
  v_and_b32 v35, 0x7fffffff, v35
  buffer_store_dwordx4 v[32:35], v57, s[44:47], 0 offen sc1
L_nored:
  s_nop 1
  ds_read_b64_tr_b16 a[96:97], v8 offset:0
  ds_read_b64_tr_b16 a[98:99], v8 offset:1024
  ds_read_b64_tr_b16 a[100:101], v8 offset:4096
  ds_read_b64_tr_b16 a[102:103], v8 offset:5120
  ds_read_b64_tr_b16 a[104:105], v8 offset:8192
  ds_read_b64_tr_b16 a[106:107], v8 offset:9216
  ds_read_b64_tr_b16 a[108:109], v8 offset:12288
  ds_read_b64_tr_b16 a[110:111], v8 offset:13312
  ds_read_b64_tr_b16 a[112:113], v8 offset:16384
  ds_read_b64_tr_b16 a[114:115], v8 offset:17408
  ds_read_b64_tr_b16 a[116:117], v8 offset:20480
  ds_read_b64_tr_b16 a[118:119], v8 offset:21504
  ds_read_b64_tr_b16 a[120:121], v8 offset:24576
  ds_read_b64_tr_b16 a[122:123], v8 offset:25600
  ds_read_b64_tr_b16 a[124:125], v8 offset:28672
  ds_read_b64_tr_b16 a[126:127], v8 offset:29696
  ds_read_b64_tr_b16 a[128:129], v8 offset:32768
  ds_read_b64_tr_b16 a[130:131], v8 offset:33792
  ds_read_b64_tr_b16 a[132:133], v8 offset:36864
  ds_read_b64_tr_b16 a[134:135], v8 offset:37888
  ds_read_b64_tr_b16 a[136:137], v8 offset:40960
  ds_read_b64_tr_b16 a[138:139], v8 offset:41984
  ds_read_b64_tr_b16 a[140:141], v8 offset:45056
  ds_read_b64_tr_b16 a[142:143], v8 offset:46080
  ds_read_b64_tr_b16 a[144:145], v11 offset:0
  ds_read_b64_tr_b16 a[146:147], v11 offset:64
  ds_read_b64_tr_b16 a[148:149], v11 offset:256
  ds_read_b64_tr_b16 a[150:151], v11 offset:320
  ds_read_b64_tr_b16 a[152:153], v11 offset:512
  ds_read_b64_tr_b16 a[154:155], v11 offset:576
  ds_read_b64_tr_b16 a[156:157], v11 offset:768
  ds_read_b64_tr_b16 a[158:159], v11 offset:832
  ds_read_b64_tr_b16 a[160:161], v11 offset:1024
  ds_read_b64_tr_b16 a[162:163], v11 offset:1088
  ds_read_b64_tr_b16 a[164:165], v11 offset:1280
  ds_read_b64_tr_b16 a[166:167], v11 offset:1344
  ds_read_b64_tr_b16 a[168:169], v11 offset:1536
  ds_read_b64_tr_b16 a[170:171], v11 offset:1600
  ds_read_b64_tr_b16 a[172:173], v11 offset:1792
  ds_read_b64_tr_b16 a[174:175], v11 offset:1856
  ds_read_b64_tr_b16 a[176:177], v11 offset:2048
  ds_read_b64_tr_b16 a[178:179], v11 offset:2112
  ds_read_b64_tr_b16 a[180:181], v11 offset:2304
  ds_read_b64_tr_b16 a[182:183], v11 offset:2368
  ds_read_b64_tr_b16 a[184:185], v11 offset:2560
  ds_read_b64_tr_b16 a[186:187], v11 offset:2624
  ds_read_b64_tr_b16 a[188:189], v11 offset:2816
  ds_read_b64_tr_b16 a[190:191], v11 offset:2880
  v_add_u32 v26, 4096, v26
  v_lshlrev_b32 v32, 16, v172
  v_and_b32 v33, 0xffff0000, v172
  v_lshlrev_b32 v34, 16, v173
  v_and_b32 v35, 0xffff0000, v173
  v_lshlrev_b32 v36, 16, v174
  v_and_b32 v37, 0xffff0000, v174
  v_lshlrev_b32 v38, 16, v175
  v_and_b32 v39, 0xffff0000, v175
  v_lshlrev_b32 v56, 16, v200
  v_and_b32 v57, 0xffff0000, v200
  v_lshlrev_b32 v58, 16, v201
  v_and_b32 v59, 0xffff0000, v201
  v_lshlrev_b32 v60, 16, v202
  v_and_b32 v61, 0xffff0000, v202
  v_lshlrev_b32 v62, 16, v203
  v_and_b32 v63, 0xffff0000, v203
  v_lshlrev_b32 v96, 16, v204
  v_and_b32 v97, 0xffff0000, v204
  v_lshlrev_b32 v98, 16, v205
  v_and_b32 v99, 0xffff0000, v205
  v_lshlrev_b32 v100, 16, v206
  v_and_b32 v101, 0xffff0000, v206
  v_lshlrev_b32 v102, 16, v207
  v_and_b32 v103, 0xffff0000, v207
  v_lshlrev_b32 v104, 16, v208
  v_and_b32 v105, 0xffff0000, v208
  v_lshlrev_b32 v106, 16, v209
  v_and_b32 v107, 0xffff0000, v209
  v_lshlrev_b32 v108, 16, v210
  v_and_b32 v109, 0xffff0000, v210
  v_lshlrev_b32 v110, 16, v211
  v_and_b32 v111, 0xffff0000, v211
  v_lshlrev_b32 v144, 16, v212
  v_and_b32 v145, 0xffff0000, v212
  v_lshlrev_b32 v146, 16, v213
  v_and_b32 v147, 0xffff0000, v213
  v_lshlrev_b32 v148, 16, v214
  v_and_b32 v149, 0xffff0000, v214
  v_lshlrev_b32 v150, 16, v215
  v_and_b32 v151, 0xffff0000, v215
  v_lshlrev_b32 v152, 16, v216
  v_and_b32 v153, 0xffff0000, v216
  v_lshlrev_b32 v154, 16, v217
  v_and_b32 v155, 0xffff0000, v217
  v_lshlrev_b32 v156, 16, v218
  v_and_b32 v157, 0xffff0000, v218
  v_lshlrev_b32 v158, 16, v219
  v_and_b32 v159, 0xffff0000, v219
  v_lshlrev_b32 v64, 16, v220
  v_and_b32 v65, 0xffff0000, v220
  v_lshlrev_b32 v66, 16, v221
  v_and_b32 v67, 0xffff0000, v221
  v_lshlrev_b32 v68, 16, v222
  v_and_b32 v69, 0xffff0000, v222
  v_lshlrev_b32 v70, 16, v223
  v_and_b32 v71, 0xffff0000, v223
  v_lshlrev_b32 v72, 16, v224
  v_and_b32 v73, 0xffff0000, v224
  v_lshlrev_b32 v74, 16, v225
  v_and_b32 v75, 0xffff0000, v225
  v_lshlrev_b32 v76, 16, v226
  v_and_b32 v77, 0xffff0000, v226
  v_lshlrev_b32 v78, 16, v227
  v_and_b32 v79, 0xffff0000, v227
  v_lshlrev_b32 v112, 16, v228
  v_and_b32 v113, 0xffff0000, v228
  v_lshlrev_b32 v114, 16, v229
  v_and_b32 v115, 0xffff0000, v229
  v_lshlrev_b32 v116, 16, v230
  v_and_b32 v117, 0xffff0000, v230
  v_lshlrev_b32 v118, 16, v231
  v_and_b32 v119, 0xffff0000, v231
  v_lshlrev_b32 v120, 16, v232
  v_and_b32 v121, 0xffff0000, v232
  v_lshlrev_b32 v122, 16, v233
  v_and_b32 v123, 0xffff0000, v233
  v_lshlrev_b32 v124, 16, v234
  v_and_b32 v125, 0xffff0000, v234
  v_lshlrev_b32 v126, 16, v235
  v_and_b32 v127, 0xffff0000, v235
  v_lshlrev_b32 v160, 16, v236
  v_and_b32 v161, 0xffff0000, v236
  v_lshlrev_b32 v162, 16, v237
  v_and_b32 v163, 0xffff0000, v237
  v_lshlrev_b32 v164, 16, v238
  v_and_b32 v165, 0xffff0000, v238
  v_lshlrev_b32 v166, 16, v239
  v_and_b32 v167, 0xffff0000, v239
  v_lshlrev_b32 v168, 16, v240
  v_and_b32 v169, 0xffff0000, v240
  v_lshlrev_b32 v170, 16, v241
  v_and_b32 v171, 0xffff0000, v241
  v_lshlrev_b32 v172, 16, v242
  v_and_b32 v173, 0xffff0000, v242
  v_lshlrev_b32 v174, 16, v243
  v_and_b32 v175, 0xffff0000, v243
  ds_read_b128 v[200:203], v26 offset:0
  ds_read_b128 v[204:207], v26 offset:384
  ds_read_b128 v[208:211], v26 offset:768
  ds_read_b128 v[212:215], v26 offset:1152
  ds_read_b128 v[216:219], v26 offset:16
  ds_read_b128 v[220:223], v26 offset:400
  ds_read_b128 v[224:227], v26 offset:784
  ds_read_b128 v[228:231], v26 offset:1168
  ds_read_b128 v[232:235], v26 offset:128
  ds_read_b128 v[236:239], v26 offset:512
  ds_read_b128 v[240:243], v26 offset:896
  ds_read_b128 v[244:247], v26 offset:1280
  v_lshlrev_b32 v40, 16, v176
  v_and_b32 v41, 0xffff0000, v176
  v_lshlrev_b32 v42, 16, v177
  v_and_b32 v43, 0xffff0000, v177
  v_lshlrev_b32 v44, 16, v178
  v_and_b32 v45, 0xffff0000, v178
  v_lshlrev_b32 v46, 16, v179
  v_and_b32 v47, 0xffff0000, v179
  v_lshlrev_b32 v80, 16, v180
  v_and_b32 v81, 0xffff0000, v180
  v_lshlrev_b32 v82, 16, v181
  v_and_b32 v83, 0xffff0000, v181
  v_lshlrev_b32 v84, 16, v182
  v_and_b32 v85, 0xffff0000, v182
  v_lshlrev_b32 v86, 16, v183
  v_and_b32 v87, 0xffff0000, v183
  v_lshlrev_b32 v88, 16, v184
  v_and_b32 v89, 0xffff0000, v184
  v_lshlrev_b32 v90, 16, v185
  v_and_b32 v91, 0xffff0000, v185
  v_lshlrev_b32 v92, 16, v186
  v_and_b32 v93, 0xffff0000, v186
  v_lshlrev_b32 v94, 16, v187
  v_and_b32 v95, 0xffff0000, v187
  v_lshlrev_b32 v128, 16, v188
  v_and_b32 v129, 0xffff0000, v188
  v_lshlrev_b32 v130, 16, v189
  v_and_b32 v131, 0xffff0000, v189
  v_lshlrev_b32 v132, 16, v190
  v_and_b32 v133, 0xffff0000, v190
  v_lshlrev_b32 v134, 16, v191
  v_and_b32 v135, 0xffff0000, v191
  v_lshlrev_b32 v136, 16, v192
  v_and_b32 v137, 0xffff0000, v192
  v_lshlrev_b32 v138, 16, v193
  v_and_b32 v139, 0xffff0000, v193
  v_lshlrev_b32 v140, 16, v194
  v_and_b32 v141, 0xffff0000, v194
  v_lshlrev_b32 v142, 16, v195
  v_and_b32 v143, 0xffff0000, v195
  v_lshlrev_b32 v48, 16, v196
  v_and_b32 v49, 0xffff0000, v196
  v_lshlrev_b32 v50, 16, v197
  v_and_b32 v51, 0xffff0000, v197
  v_lshlrev_b32 v52, 16, v198
  v_and_b32 v53, 0xffff0000, v198
  v_lshlrev_b32 v54, 16, v199
  v_and_b32 v55, 0xffff0000, v199
  s_waitcnt lgkmcnt(8)
  v_pk_add_f32 v[176:177], v[200:201], v[204:205]
  v_pk_add_f32 v[208:209], v[208:209], v[212:213]
  v_pk_add_f32 v[176:177], v[176:177], v[208:209]
  v_pk_add_f32 v[178:179], v[202:203], v[206:207]
  v_pk_add_f32 v[210:211], v[210:211], v[214:215]
  v_pk_add_f32 v[178:179], v[178:179], v[210:211]
  s_waitcnt lgkmcnt(4)
  v_pk_add_f32 v[180:181], v[216:217], v[220:221]
  v_pk_add_f32 v[224:225], v[224:225], v[228:229]
  v_pk_add_f32 v[180:181], v[180:181], v[224:225]
  v_pk_add_f32 v[182:183], v[218:219], v[222:223]
  v_pk_add_f32 v[226:227], v[226:227], v[230:231]
  v_pk_add_f32 v[182:183], v[182:183], v[226:227]
  s_waitcnt lgkmcnt(0)
  v_pk_add_f32 v[184:185], v[232:233], v[236:237]
  v_pk_add_f32 v[240:241], v[240:241], v[244:245]
  v_pk_add_f32 v[184:185], v[184:185], v[240:241]
  v_pk_add_f32 v[186:187], v[234:235], v[238:239]
  v_pk_add_f32 v[242:243], v[242:243], v[246:247]
  v_pk_add_f32 v[186:187], v[186:187], v[242:243]
  ds_read_b128 v[200:203], v26 offset:144
  ds_read_b128 v[204:207], v26 offset:528
  ds_read_b128 v[208:211], v26 offset:912
  ds_read_b128 v[212:215], v26 offset:1296
  ds_read_b128 v[216:219], v26 offset:256
  ds_read_b128 v[220:223], v26 offset:640
  ds_read_b128 v[224:227], v26 offset:1024
  ds_read_b128 v[228:231], v26 offset:1408
  ds_read_b128 v[232:235], v26 offset:272
  ds_read_b128 v[236:239], v26 offset:656
  ds_read_b128 v[240:243], v26 offset:1040
  ds_read_b128 v[244:247], v26 offset:1424
  v_mov_b32 v7, v24
  v_mov_b32 v8, v23
  v_mov_b32 v9, v27
  s_waitcnt vmcnt(0)
  s_mov_b32 s62, 0xc0088e99
  v_lshlrev_b32 v24, 16, v2
  v_and_b32 v25, 0xffff0000, v2
  v_lshlrev_b32 v26, 16, v3
  v_and_b32 v27, 0xffff0000, v3
  v_mul_f32 v24, s62, v24
  v_mul_f32 v25, s62, v25
  v_mul_f32 v26, s62, v26
  v_mul_f32 v27, s62, v27
  v_lshlrev_b32 v28, 16, v4
  v_and_b32 v29, 0xffff0000, v4
  v_lshlrev_b32 v30, 16, v5
  v_and_b32 v31, 0xffff0000, v5
  v_mul_f32 v28, s62, v28
  v_mul_f32 v29, s62, v29
  v_mul_f32 v30, s62, v30
  v_mul_f32 v31, s62, v31
  s_mul_i32 s62, s22, 6144
  v_add_u32 v3, s62, v8
  s_mul_i32 s62, s79, 24576
  v_add_u32 v2, s62, v8
  v_add_u32 v6, 49152, v8
  v_add_u32 v4, s69, v8
  v_add_u32 v5, 73728, v8
  v_and_b32 v22, 15, v1
  v_lshrrev_b32 v23, 4, v1
  v_lshrrev_b32 v0, 2, v22
  v_and_b32 v10, 1, v22
  v_lshlrev_b32 v10, 4, v10
  v_mov_b32 v11, 0x3f80
  v_lshlrev_b32 v10, v10, v11
  v_cmp_eq_u32 vcc, v23, v0
  s_nop 1
  v_cndmask_b32 v10, 0, v10, vcc
  v_and_b32 v0, 2, v22
  v_cmp_eq_u32 vcc, 0, v0
  v_mov_b32 v16, 0
  v_mov_b32 v17, 0
  v_mov_b32 v20, 0
  v_mov_b32 v21, 0
  v_cndmask_b32 v18, 0, v10, vcc
  v_cndmask_b32 v19, v10, 0, vcc
  s_waitcnt lgkmcnt(8)
  v_pk_add_f32 v[188:189], v[200:201], v[204:205]
  v_pk_add_f32 v[208:209], v[208:209], v[212:213]
  v_pk_add_f32 v[188:189], v[188:189], v[208:209]
  v_pk_add_f32 v[190:191], v[202:203], v[206:207]
  v_pk_add_f32 v[210:211], v[210:211], v[214:215]
  v_pk_add_f32 v[190:191], v[190:191], v[210:211]
  s_waitcnt lgkmcnt(4)
  v_pk_add_f32 v[192:193], v[216:217], v[220:221]
  v_pk_add_f32 v[224:225], v[224:225], v[228:229]
  v_pk_add_f32 v[192:193], v[192:193], v[224:225]
  v_pk_add_f32 v[194:195], v[218:219], v[222:223]
  v_pk_add_f32 v[226:227], v[226:227], v[230:231]
  v_pk_add_f32 v[194:195], v[194:195], v[226:227]
  s_waitcnt lgkmcnt(0)
  v_pk_add_f32 v[196:197], v[232:233], v[236:237]
  v_pk_add_f32 v[240:241], v[240:241], v[244:245]
  v_pk_add_f32 v[196:197], v[196:197], v[240:241]
  v_pk_add_f32 v[198:199], v[234:235], v[238:239]
  v_pk_add_f32 v[242:243], v[242:243], v[246:247]
  v_pk_add_f32 v[198:199], v[198:199], v[242:243]
  v_mfma_f32_16x16x32_bf16 v[200:203], v[18:21], a[204:207], v[176:179]
  v_mfma_f32_16x16x32_bf16 v[204:207], v[16:19], a[204:207], v[180:183]
  v_mfma_f32_16x16x32_bf16 v[208:211], v[18:21], a[208:211], v[184:187]
  v_mfma_f32_16x16x32_bf16 v[212:215], v[16:19], a[208:211], v[188:191]
  v_mfma_f32_16x16x32_bf16 v[216:219], v[18:21], a[212:215], v[192:195]
  v_mfma_f32_16x16x32_bf16 v[220:223], v[16:19], a[212:215], v[196:199]
  v_mfma_f32_16x16x32_bf16 v[224:227], v[18:21], a[216:219], v[176:179]
  v_mfma_f32_16x16x32_bf16 v[228:231], v[16:19], a[216:219], v[180:183]
  v_mfma_f32_16x16x32_bf16 v[232:235], v[18:21], a[220:223], v[184:187]
  v_mfma_f32_16x16x32_bf16 v[236:239], v[16:19], a[220:223], v[188:191]
  v_mfma_f32_16x16x32_bf16 v[240:243], v[18:21], a[224:227], v[192:195]
  v_mfma_f32_16x16x32_bf16 v[244:247], v[16:19], a[224:227], v[196:199]
  s_cmp_lg_u32 s79, 0
  s_cbranch_scc1 L_rb0
  v_mfma_f32_16x16x32_bf16 v[248:251], v[18:21], a[228:231], v[176:179]
  v_mfma_f32_16x16x32_bf16 v[252:255], v[16:19], a[228:231], v[180:183]
L_rb0:
  s_cmp_lg_u32 s79, 1
  s_cbranch_scc1 L_rb1
  s_nop 5
  v_mfma_f32_16x16x32_bf16 v[248:251], v[18:21], a[228:231], v[184:187]
  v_mfma_f32_16x16x32_bf16 v[252:255], v[16:19], a[228:231], v[188:191]
L_rb1:
  s_cmp_lg_u32 s79, 2
  s_cbranch_scc1 L_rb2
  s_nop 5
  v_mfma_f32_16x16x32_bf16 v[248:251], v[18:21], a[228:231], v[192:195]
  v_mfma_f32_16x16x32_bf16 v[252:255], v[16:19], a[228:231], v[196:199]
L_rb2:
  v_mfma_f32_16x16x32_bf16 v[176:179], v[18:21], a[192:195], v[176:179]
  v_mfma_f32_16x16x32_bf16 v[180:183], v[16:19], a[192:195], v[180:183]
  v_mfma_f32_16x16x32_bf16 v[184:187], v[18:21], a[196:199], v[184:187]
  v_mfma_f32_16x16x32_bf16 v[188:191], v[16:19], a[196:199], v[188:191]
  v_mfma_f32_16x16x32_bf16 v[192:195], v[18:21], a[200:203], v[192:195]
  v_mfma_f32_16x16x32_bf16 v[196:199], v[16:19], a[200:203], v[196:199]
  s_waitcnt lgkmcnt(0)
  s_cmp_lg_u32 s22, 0
  s_cbranch_scc1 L_tot_done
  s_mov_b32 s78, 400000
  s_mov_b32 s4, 0xc0088e99
  s_mov_b32 s5, 0xc0088e99
  s_mov_b32 s6, 0x4091afa4
  s_mov_b32 s7, 0x4091afa4
  s_mov_b32 s8, 0x3b2aaaab
  s_mov_b32 s9, 0x358637bd
  v_mov_b32 v10, s9
  v_mov_b32 v11, s9
L_tot:
  buffer_load_dwordx4 v[16:19], v4, s[44:47], 0 offen sc1
  buffer_load_dwordx4 v[20:23], v9, s[44:47], 0 offen offset:1024 sc1
  s_waitcnt vmcnt(0)
  v_max3_u32 v0, v16, v17, v18
  v_max3_u32 v0, v0, v19, v20
  v_max3_u32 v0, v0, v21, v22
  v_max_u32 v0, v0, v23
  v_cmp_eq_u32 vcc, -1, v0
  s_cbranch_vccz L_tot_got
  s_sub_u32 s78, s78, 1
  s_cmp_lg_u32 s78, 0
  s_cbranch_scc1 L_tot
L_tot_got:
  v_pk_fma_f32 v[16:17], v[16:17], s[6:7], v[10:11]
  v_pk_fma_f32 v[18:19], v[18:19], s[6:7], v[10:11]
  v_pk_fma_f32 v[20:21], v[20:21], s[6:7], v[10:11]
  v_pk_fma_f32 v[22:23], v[22:23], s[6:7], v[10:11]
  v_sqrt_f32 v16, v16
  v_sqrt_f32 v17, v17
  v_sqrt_f32 v18, v18
  v_sqrt_f32 v19, v19
  v_sqrt_f32 v20, v20
  v_sqrt_f32 v21, v21
  v_sqrt_f32 v22, v22
  v_sqrt_f32 v23, v23
  v_cmp_gt_u32 vcc, 32, v1
  v_pk_add_f32 v[10:11], v[20:21], v[22:23]
  v_add_f32 v10, v10, v11
  v_cndmask_b32 v0, 0, v10, vcc
  v_pk_add_f32 v[10:11], v[16:17], v[18:19]
  v_add_f32 v10, v10, v11
  v_add_f32 v0, v0, v10
  v_pk_mul_f32 v[24:25], v[24:25], v[16:17]
  s_nop 0
  v_add_f32_dpp v0, v0, v0 row_shr:1 row_mask:0xf bank_mask:0xf bound_ctrl:1
  v_pk_mul_f32 v[26:27], v[26:27], v[18:19]
  s_nop 0
  v_add_f32_dpp v0, v0, v0 row_shr:2 row_mask:0xf bank_mask:0xf bound_ctrl:1
  v_pk_mul_f32 v[28:29], v[28:29], v[20:21]
  s_nop 0
  v_add_f32_dpp v0, v0, v0 row_shr:4 row_mask:0xf bank_mask:0xf bound_ctrl:1
  v_pk_mul_f32 v[30:31], v[30:31], v[22:23]
  s_nop 0
  v_add_f32_dpp v0, v0, v0 row_shr:8 row_mask:0xf bank_mask:0xf bound_ctrl:1
  s_nop 1
  v_add_f32_dpp v0, v0, v0 row_bcast:15 row_mask:0xa bank_mask:0xf
  s_nop 1
  v_add_f32_dpp v0, v0, v0 row_bcast:31 row_mask:0xc bank_mask:0xf
  s_nop 0
  v_readlane_b32 s64, v0, 63
  v_mov_b32 v10, s9
  s_nop 0
  v_mov_b32 v11, s64
  v_fma_f32 v10, v11, s8, v10
  v_rcp_f32 v10, v10
  s_nop 0
  v_pk_fma_f32 v[16:17], v[24:25], v[10:11], s[4:5] op_sel_hi:[1,0,1]
  v_pk_fma_f32 v[18:19], v[26:27], v[10:11], s[4:5] op_sel_hi:[1,0,1]
  v_pk_fma_f32 v[20:21], v[28:29], v[10:11], s[4:5] op_sel_hi:[1,0,1]
  v_pk_fma_f32 v[22:23], v[30:31], v[10:11], s[4:5] op_sel_hi:[1,0,1]
  ds_write_b128 v5, v[16:19]
  s_mov_b32 exec_hi, 0
  ds_write_b128 v5, v[20:23] offset:1024
  s_mov_b64 exec, -1
  s_waitcnt lgkmcnt(0)
L_tot_done:
  s_barrier
  ds_read_b128 v[16:19], v7 offset:0
  ds_read_b128 v[20:23], v7 offset:32
  ds_read_b128 v[24:27], v7 offset:128
  ds_read_b128 v[28:31], v7 offset:160
  s_waitcnt lgkmcnt(2)
  v_pk_mul_f32 v[32:33], v[32:33], v[16:17]
  v_pk_mul_f32 v[34:35], v[34:35], v[18:19]
  v_pk_mul_f32 v[36:37], v[36:37], v[20:21]
  v_pk_mul_f32 v[38:39], v[38:39], v[22:23]
  v_cvt_pk_bf16_f32 v32, v32, v33
  v_cvt_pk_bf16_f32 v33, v34, v35
  v_cvt_pk_bf16_f32 v34, v36, v37
  v_cvt_pk_bf16_f32 v35, v38, v39
  ds_write_b128 v3, v[32:35] offset:0
  v_pk_mul_f32 v[40:41], v[40:41], v[16:17]
  v_pk_mul_f32 v[42:43], v[42:43], v[18:19]
  v_pk_mul_f32 v[44:45], v[44:45], v[20:21]
  v_pk_mul_f32 v[46:47], v[46:47], v[22:23]
  v_cvt_pk_bf16_f32 v40, v40, v41
  v_cvt_pk_bf16_f32 v41, v42, v43
  v_cvt_pk_bf16_f32 v42, v44, v45
  v_cvt_pk_bf16_f32 v43, v46, v47
  ds_write_b128 v3, v[40:43] offset:1024
  ds_read_b128 v[40:43], v7 offset:256
  ds_read_b128 v[44:47], v7 offset:288
  s_waitcnt lgkmcnt(4)
  v_pk_mul_f32 v[48:49], v[48:49], v[24:25]
  v_pk_mul_f32 v[50:51], v[50:51], v[26:27]
  v_pk_mul_f32 v[52:53], v[52:53], v[28:29]
  v_pk_mul_f32 v[54:55], v[54:55], v[30:31]
  v_cvt_pk_bf16_f32 v48, v48, v49
  v_cvt_pk_bf16_f32 v49, v50, v51
  v_cvt_pk_bf16_f32 v50, v52, v53
  v_cvt_pk_bf16_f32 v51, v54, v55
  ds_write_b128 v3, v[48:51] offset:2048
  v_pk_mul_f32 v[56:57], v[56:57], v[24:25]
  v_pk_mul_f32 v[58:59], v[58:59], v[26:27]
  v_pk_mul_f32 v[60:61], v[60:61], v[28:29]
  v_pk_mul_f32 v[62:63], v[62:63], v[30:31]
  v_cvt_pk_bf16_f32 v56, v56, v57
  v_cvt_pk_bf16_f32 v57, v58, v59
  v_cvt_pk_bf16_f32 v58, v60, v61
  v_cvt_pk_bf16_f32 v59, v62, v63
  ds_write_b128 v3, v[56:59] offset:3072
  s_waitcnt lgkmcnt(2)
  v_pk_mul_f32 v[64:65], v[64:65], v[40:41]
  v_pk_mul_f32 v[66:67], v[66:67], v[42:43]
  v_pk_mul_f32 v[68:69], v[68:69], v[44:45]
  v_pk_mul_f32 v[70:71], v[70:71], v[46:47]
  v_cvt_pk_bf16_f32 v64, v64, v65
  v_cvt_pk_bf16_f32 v65, v66, v67
  v_cvt_pk_bf16_f32 v66, v68, v69
  v_cvt_pk_bf16_f32 v67, v70, v71
  ds_write_b128 v3, v[64:67] offset:4096
  v_pk_mul_f32 v[72:73], v[72:73], v[40:41]
  v_pk_mul_f32 v[74:75], v[74:75], v[42:43]
  v_pk_mul_f32 v[76:77], v[76:77], v[44:45]
  v_pk_mul_f32 v[78:79], v[78:79], v[46:47]
  v_cvt_pk_bf16_f32 v72, v72, v73
  v_cvt_pk_bf16_f32 v73, v74, v75
  v_cvt_pk_bf16_f32 v74, v76, v77
  v_cvt_pk_bf16_f32 v75, v78, v79
  ds_write_b128 v3, v[72:75] offset:5120
  v_pk_mul_f32 v[80:81], v[80:81], v[16:17]
  v_pk_mul_f32 v[82:83], v[82:83], v[18:19]
  v_pk_mul_f32 v[84:85], v[84:85], v[20:21]
  v_pk_mul_f32 v[86:87], v[86:87], v[22:23]
  v_cvt_pk_bf16_f32 v80, v80, v81
  v_cvt_pk_bf16_f32 v81, v82, v83
  v_cvt_pk_bf16_f32 v82, v84, v85
  v_cvt_pk_bf16_f32 v83, v86, v87
  ds_write_b128 v3, v[80:83] offset:24576
  v_pk_mul_f32 v[88:89], v[88:89], v[16:17]
  v_pk_mul_f32 v[90:91], v[90:91], v[18:19]
  v_pk_mul_f32 v[92:93], v[92:93], v[20:21]
  v_pk_mul_f32 v[94:95], v[94:95], v[22:23]
  v_cvt_pk_bf16_f32 v88, v88, v89
  v_cvt_pk_bf16_f32 v89, v90, v91
  v_cvt_pk_bf16_f32 v90, v92, v93
  v_cvt_pk_bf16_f32 v91, v94, v95
  ds_write_b128 v3, v[88:91] offset:25600
  v_pk_mul_f32 v[96:97], v[96:97], v[24:25]
  v_pk_mul_f32 v[98:99], v[98:99], v[26:27]
  v_pk_mul_f32 v[100:101], v[100:101], v[28:29]
  v_pk_mul_f32 v[102:103], v[102:103], v[30:31]
  v_cvt_pk_bf16_f32 v96, v96, v97
  v_cvt_pk_bf16_f32 v97, v98, v99
  v_cvt_pk_bf16_f32 v98, v100, v101
  v_cvt_pk_bf16_f32 v99, v102, v103
  ds_write_b128 v3, v[96:99] offset:26624
  v_pk_mul_f32 v[104:105], v[104:105], v[24:25]
  v_pk_mul_f32 v[106:107], v[106:107], v[26:27]
  v_pk_mul_f32 v[108:109], v[108:109], v[28:29]
  v_pk_mul_f32 v[110:111], v[110:111], v[30:31]
  v_cvt_pk_bf16_f32 v104, v104, v105
  v_cvt_pk_bf16_f32 v105, v106, v107
  v_cvt_pk_bf16_f32 v106, v108, v109
  v_cvt_pk_bf16_f32 v107, v110, v111
  ds_write_b128 v3, v[104:107] offset:27648
  v_pk_mul_f32 v[112:113], v[112:113], v[40:41]
  v_pk_mul_f32 v[114:115], v[114:115], v[42:43]
  v_pk_mul_f32 v[116:117], v[116:117], v[44:45]
  v_pk_mul_f32 v[118:119], v[118:119], v[46:47]
  v_cvt_pk_bf16_f32 v112, v112, v113
  v_cvt_pk_bf16_f32 v113, v114, v115
  v_cvt_pk_bf16_f32 v114, v116, v117
  v_cvt_pk_bf16_f32 v115, v118, v119
  ds_write_b128 v3, v[112:115] offset:28672
  v_pk_mul_f32 v[120:121], v[120:121], v[40:41]
  v_pk_mul_f32 v[122:123], v[122:123], v[42:43]
  v_pk_mul_f32 v[124:125], v[124:125], v[44:45]
  v_pk_mul_f32 v[126:127], v[126:127], v[46:47]
  v_cvt_pk_bf16_f32 v120, v120, v121
  v_cvt_pk_bf16_f32 v121, v122, v123
  v_cvt_pk_bf16_f32 v122, v124, v125
  v_cvt_pk_bf16_f32 v123, v126, v127
  ds_write_b128 v3, v[120:123] offset:29696
  v_pk_mul_f32 v[128:129], v[128:129], v[16:17]
  v_pk_mul_f32 v[130:131], v[130:131], v[18:19]
  v_pk_mul_f32 v[132:133], v[132:133], v[20:21]
  v_pk_mul_f32 v[134:135], v[134:135], v[22:23]
  v_cvt_pk_bf16_f32 v128, v128, v129
  v_cvt_pk_bf16_f32 v129, v130, v131
  v_cvt_pk_bf16_f32 v130, v132, v133
  v_cvt_pk_bf16_f32 v131, v134, v135
  ds_write_b128 v3, v[128:131] offset:49152
  v_pk_mul_f32 v[136:137], v[136:137], v[16:17]
  v_pk_mul_f32 v[138:139], v[138:139], v[18:19]
  v_pk_mul_f32 v[140:141], v[140:141], v[20:21]
  v_pk_mul_f32 v[142:143], v[142:143], v[22:23]
  v_cvt_pk_bf16_f32 v136, v136, v137
  v_cvt_pk_bf16_f32 v137, v138, v139
  v_cvt_pk_bf16_f32 v138, v140, v141
  v_cvt_pk_bf16_f32 v139, v142, v143
  ds_write_b128 v3, v[136:139] offset:50176
  v_pk_mul_f32 v[144:145], v[144:145], v[24:25]
  v_pk_mul_f32 v[146:147], v[146:147], v[26:27]
  v_pk_mul_f32 v[148:149], v[148:149], v[28:29]
  v_pk_mul_f32 v[150:151], v[150:151], v[30:31]
  v_cvt_pk_bf16_f32 v144, v144, v145
  v_cvt_pk_bf16_f32 v145, v146, v147
  v_cvt_pk_bf16_f32 v146, v148, v149
  v_cvt_pk_bf16_f32 v147, v150, v151
  ds_write_b128 v3, v[144:147] offset:51200
  v_pk_mul_f32 v[152:153], v[152:153], v[24:25]
  v_pk_mul_f32 v[154:155], v[154:155], v[26:27]
  v_pk_mul_f32 v[156:157], v[156:157], v[28:29]
  v_pk_mul_f32 v[158:159], v[158:159], v[30:31]
  v_cvt_pk_bf16_f32 v152, v152, v153
  v_cvt_pk_bf16_f32 v153, v154, v155
  v_cvt_pk_bf16_f32 v154, v156, v157
  v_cvt_pk_bf16_f32 v155, v158, v159
  ds_write_b128 v3, v[152:155] offset:52224
  v_pk_mul_f32 v[160:161], v[160:161], v[40:41]
  v_pk_mul_f32 v[162:163], v[162:163], v[42:43]
  v_pk_mul_f32 v[164:165], v[164:165], v[44:45]
  v_pk_mul_f32 v[166:167], v[166:167], v[46:47]
  v_cvt_pk_bf16_f32 v160, v160, v161
  v_cvt_pk_bf16_f32 v161, v162, v163
  v_cvt_pk_bf16_f32 v162, v164, v165
  v_cvt_pk_bf16_f32 v163, v166, v167
  ds_write_b128 v3, v[160:163] offset:53248
  v_pk_mul_f32 v[168:169], v[168:169], v[40:41]
  v_pk_mul_f32 v[170:171], v[170:171], v[42:43]
  v_pk_mul_f32 v[172:173], v[172:173], v[44:45]
  v_pk_mul_f32 v[174:175], v[174:175], v[46:47]
  v_cvt_pk_bf16_f32 v168, v168, v169
  v_cvt_pk_bf16_f32 v169, v170, v171
  v_cvt_pk_bf16_f32 v170, v172, v173
  v_cvt_pk_bf16_f32 v171, v174, v175
  ds_write_b128 v3, v[168:171] offset:54272
  s_waitcnt lgkmcnt(0)
  s_barrier
  ds_read_b128 v[48:51], v8 offset:0
  ds_read_b128 v[52:55], v8 offset:1024
  ds_read_b128 v[56:59], v8 offset:2048
  ds_read_b128 v[60:63], v8 offset:3072
  ds_read_b128 v[64:67], v8 offset:4096
  ds_read_b128 v[68:71], v8 offset:5120
  ds_read_b128 v[72:75], v8 offset:6144
  ds_read_b128 v[76:79], v8 offset:7168
  s_waitcnt lgkmcnt(4)
  v_mfma_f32_16x16x32_bf16 v[176:179], v[48:51], a[0:3], v[176:179]
  v_mfma_f32_16x16x32_bf16 v[180:183], v[52:55], a[0:3], v[180:183]
  v_mfma_f32_16x16x32_bf16 v[200:203], v[48:51], a[48:51], v[200:203]
  v_mfma_f32_16x16x32_bf16 v[204:207], v[52:55], a[48:51], v[204:207]
  v_mfma_f32_16x16x32_bf16 v[224:227], v[48:51], a[96:99], v[224:227]
  v_mfma_f32_16x16x32_bf16 v[228:231], v[52:55], a[96:99], v[228:231]
  v_mfma_f32_16x16x32_bf16 v[176:179], v[56:59], a[4:7], v[176:179]
  v_mfma_f32_16x16x32_bf16 v[180:183], v[60:63], a[4:7], v[180:183]
  v_mfma_f32_16x16x32_bf16 v[200:203], v[56:59], a[52:55], v[200:203]
  v_mfma_f32_16x16x32_bf16 v[204:207], v[60:63], a[52:55], v[204:207]
  v_mfma_f32_16x16x32_bf16 v[224:227], v[56:59], a[100:103], v[224:227]
  v_mfma_f32_16x16x32_bf16 v[228:231], v[60:63], a[100:103], v[228:231]
  ds_read_b128 v[48:51], v8 offset:8192
  ds_read_b128 v[52:55], v8 offset:9216
  ds_read_b128 v[56:59], v8 offset:10240
  ds_read_b128 v[60:63], v8 offset:11264
  s_waitcnt lgkmcnt(4)
  v_mfma_f32_16x16x32_bf16 v[176:179], v[64:67], a[8:11], v[176:179]
  v_mfma_f32_16x16x32_bf16 v[180:183], v[68:71], a[8:11], v[180:183]
  v_mfma_f32_16x16x32_bf16 v[200:203], v[64:67], a[56:59], v[200:203]
  v_mfma_f32_16x16x32_bf16 v[204:207], v[68:71], a[56:59], v[204:207]
  v_mfma_f32_16x16x32_bf16 v[224:227], v[64:67], a[104:107], v[224:227]
  v_mfma_f32_16x16x32_bf16 v[228:231], v[68:71], a[104:107], v[228:231]
  v_mfma_f32_16x16x32_bf16 v[176:179], v[72:75], a[12:15], v[176:179]
  v_mfma_f32_16x16x32_bf16 v[180:183], v[76:79], a[12:15], v[180:183]
  v_mfma_f32_16x16x32_bf16 v[200:203], v[72:75], a[60:63], v[200:203]
  v_mfma_f32_16x16x32_bf16 v[204:207], v[76:79], a[60:63], v[204:207]
  v_mfma_f32_16x16x32_bf16 v[224:227], v[72:75], a[108:111], v[224:227]
  v_mfma_f32_16x16x32_bf16 v[228:231], v[76:79], a[108:111], v[228:231]
  ds_read_b128 v[64:67], v8 offset:12288
  ds_read_b128 v[68:71], v8 offset:13312
  ds_read_b128 v[72:75], v8 offset:14336
  ds_read_b128 v[76:79], v8 offset:15360
  s_waitcnt lgkmcnt(4)
  v_mfma_f32_16x16x32_bf16 v[176:179], v[48:51], a[16:19], v[176:179]
  v_mfma_f32_16x16x32_bf16 v[180:183], v[52:55], a[16:19], v[180:183]
  v_mfma_f32_16x16x32_bf16 v[200:203], v[48:51], a[64:67], v[200:203]
  v_mfma_f32_16x16x32_bf16 v[204:207], v[52:55], a[64:67], v[204:207]
  v_mfma_f32_16x16x32_bf16 v[224:227], v[48:51], a[112:115], v[224:227]
  v_mfma_f32_16x16x32_bf16 v[228:231], v[52:55], a[112:115], v[228:231]
  v_mfma_f32_16x16x32_bf16 v[176:179], v[56:59], a[20:23], v[176:179]
  v_mfma_f32_16x16x32_bf16 v[180:183], v[60:63], a[20:23], v[180:183]
  v_mfma_f32_16x16x32_bf16 v[200:203], v[56:59], a[68:71], v[200:203]
  v_mfma_f32_16x16x32_bf16 v[204:207], v[60:63], a[68:71], v[204:207]
  v_mfma_f32_16x16x32_bf16 v[224:227], v[56:59], a[116:119], v[224:227]
  v_mfma_f32_16x16x32_bf16 v[228:231], v[60:63], a[116:119], v[228:231]
  ds_read_b128 v[48:51], v8 offset:16384
  ds_read_b128 v[52:55], v8 offset:17408
  ds_read_b128 v[56:59], v8 offset:18432
  ds_read_b128 v[60:63], v8 offset:19456
  s_waitcnt lgkmcnt(4)
  v_mfma_f32_16x16x32_bf16 v[176:179], v[64:67], a[24:27], v[176:179]
  v_mfma_f32_16x16x32_bf16 v[180:183], v[68:71], a[24:27], v[180:183]
  v_mfma_f32_16x16x32_bf16 v[200:203], v[64:67], a[72:75], v[200:203]
  v_mfma_f32_16x16x32_bf16 v[204:207], v[68:71], a[72:75], v[204:207]
  v_mfma_f32_16x16x32_bf16 v[224:227], v[64:67], a[120:123], v[224:227]
  v_mfma_f32_16x16x32_bf16 v[228:231], v[68:71], a[120:123], v[228:231]
  v_mfma_f32_16x16x32_bf16 v[176:179], v[72:75], a[28:31], v[176:179]
  v_mfma_f32_16x16x32_bf16 v[180:183], v[76:79], a[28:31], v[180:183]
  v_mfma_f32_16x16x32_bf16 v[200:203], v[72:75], a[76:79], v[200:203]
  v_mfma_f32_16x16x32_bf16 v[204:207], v[76:79], a[76:79], v[204:207]
  v_mfma_f32_16x16x32_bf16 v[224:227], v[72:75], a[124:127], v[224:227]
  v_mfma_f32_16x16x32_bf16 v[228:231], v[76:79], a[124:127], v[228:231]
  ds_read_b128 v[64:67], v8 offset:20480
  ds_read_b128 v[68:71], v8 offset:21504
  ds_read_b128 v[72:75], v8 offset:22528
  ds_read_b128 v[76:79], v8 offset:23552
  s_waitcnt lgkmcnt(4)
  v_mfma_f32_16x16x32_bf16 v[176:179], v[48:51], a[32:35], v[176:179]
  v_mfma_f32_16x16x32_bf16 v[180:183], v[52:55], a[32:35], v[180:183]
  v_mfma_f32_16x16x32_bf16 v[200:203], v[48:51], a[80:83], v[200:203]
  v_mfma_f32_16x16x32_bf16 v[204:207], v[52:55], a[80:83], v[204:207]
  v_mfma_f32_16x16x32_bf16 v[224:227], v[48:51], a[128:131], v[224:227]
  v_mfma_f32_16x16x32_bf16 v[228:231], v[52:55], a[128:131], v[228:231]
  v_mfma_f32_16x16x32_bf16 v[176:179], v[56:59], a[36:39], v[176:179]
  v_mfma_f32_16x16x32_bf16 v[180:183], v[60:63], a[36:39], v[180:183]
  v_mfma_f32_16x16x32_bf16 v[200:203], v[56:59], a[84:87], v[200:203]
  v_mfma_f32_16x16x32_bf16 v[204:207], v[60:63], a[84:87], v[204:207]
  v_mfma_f32_16x16x32_bf16 v[224:227], v[56:59], a[132:135], v[224:227]
  v_mfma_f32_16x16x32_bf16 v[228:231], v[60:63], a[132:135], v[228:231]
  ds_read_b128 v[48:51], v8 offset:24576
  ds_read_b128 v[52:55], v8 offset:25600
  ds_read_b128 v[56:59], v8 offset:26624
  ds_read_b128 v[60:63], v8 offset:27648
  s_waitcnt lgkmcnt(4)
  v_mfma_f32_16x16x32_bf16 v[176:179], v[64:67], a[40:43], v[176:179]
  v_mfma_f32_16x16x32_bf16 v[180:183], v[68:71], a[40:43], v[180:183]
  v_mfma_f32_16x16x32_bf16 v[200:203], v[64:67], a[88:91], v[200:203]
  v_mfma_f32_16x16x32_bf16 v[204:207], v[68:71], a[88:91], v[204:207]
  v_mfma_f32_16x16x32_bf16 v[224:227], v[64:67], a[136:139], v[224:227]
  v_mfma_f32_16x16x32_bf16 v[228:231], v[68:71], a[136:139], v[228:231]
  v_mfma_f32_16x16x32_bf16 v[176:179], v[72:75], a[44:47], v[176:179]
  v_mfma_f32_16x16x32_bf16 v[180:183], v[76:79], a[44:47], v[180:183]
  v_mfma_f32_16x16x32_bf16 v[200:203], v[72:75], a[92:95], v[200:203]
  v_mfma_f32_16x16x32_bf16 v[204:207], v[76:79], a[92:95], v[204:207]
  v_mfma_f32_16x16x32_bf16 v[224:227], v[72:75], a[140:143], v[224:227]
  v_mfma_f32_16x16x32_bf16 v[228:231], v[76:79], a[140:143], v[228:231]
  ds_read_b128 v[64:67], v8 offset:28672
  ds_read_b128 v[68:71], v8 offset:29696
  ds_read_b128 v[72:75], v8 offset:30720
  ds_read_b128 v[76:79], v8 offset:31744
  s_waitcnt lgkmcnt(4)
  v_mfma_f32_16x16x32_bf16 v[184:187], v[48:51], a[0:3], v[184:187]
  v_mfma_f32_16x16x32_bf16 v[188:191], v[52:55], a[0:3], v[188:191]
  v_mfma_f32_16x16x32_bf16 v[208:211], v[48:51], a[48:51], v[208:211]
  v_mfma_f32_16x16x32_bf16 v[212:215], v[52:55], a[48:51], v[212:215]
  v_mfma_f32_16x16x32_bf16 v[232:235], v[48:51], a[96:99], v[232:235]
  v_mfma_f32_16x16x32_bf16 v[236:239], v[52:55], a[96:99], v[236:239]
  v_mfma_f32_16x16x32_bf16 v[184:187], v[56:59], a[4:7], v[184:187]
  v_mfma_f32_16x16x32_bf16 v[188:191], v[60:63], a[4:7], v[188:191]
  v_mfma_f32_16x16x32_bf16 v[208:211], v[56:59], a[52:55], v[208:211]
  v_mfma_f32_16x16x32_bf16 v[212:215], v[60:63], a[52:55], v[212:215]
  v_mfma_f32_16x16x32_bf16 v[232:235], v[56:59], a[100:103], v[232:235]
  v_mfma_f32_16x16x32_bf16 v[236:239], v[60:63], a[100:103], v[236:239]
  ds_read_b128 v[48:51], v8 offset:32768
  ds_read_b128 v[52:55], v8 offset:33792
  ds_read_b128 v[56:59], v8 offset:34816
  ds_read_b128 v[60:63], v8 offset:35840
  s_waitcnt lgkmcnt(4)
  v_mfma_f32_16x16x32_bf16 v[184:187], v[64:67], a[8:11], v[184:187]
  v_cvt_pk_bf16_f32 v176, v176, v177
  v_mfma_f32_16x16x32_bf16 v[188:191], v[68:71], a[8:11], v[188:191]
  v_cvt_pk_bf16_f32 v177, v178, v179
  v_mfma_f32_16x16x32_bf16 v[208:211], v[64:67], a[56:59], v[208:211]
  v_cvt_pk_bf16_f32 v178, v180, v181
  v_mfma_f32_16x16x32_bf16 v[212:215], v[68:71], a[56:59], v[212:215]
  v_cvt_pk_bf16_f32 v179, v182, v183
  v_mfma_f32_16x16x32_bf16 v[232:235], v[64:67], a[104:107], v[232:235]
  buffer_store_dwordx4 v[176:179], v12, s[40:43], 0 offen offset:0 sc0 sc1
  v_mfma_f32_16x16x32_bf16 v[236:239], v[68:71], a[104:107], v[236:239]
  v_cvt_pk_bf16_f32 v200, v200, v201
  v_mfma_f32_16x16x32_bf16 v[184:187], v[72:75], a[12:15], v[184:187]
  v_cvt_pk_bf16_f32 v201, v202, v203
  v_mfma_f32_16x16x32_bf16 v[188:191], v[76:79], a[12:15], v[188:191]
  v_cvt_pk_bf16_f32 v202, v204, v205
  v_mfma_f32_16x16x32_bf16 v[208:211], v[72:75], a[60:63], v[208:211]
  v_cvt_pk_bf16_f32 v203, v206, v207
  v_mfma_f32_16x16x32_bf16 v[212:215], v[76:79], a[60:63], v[212:215]
  v_mfma_f32_16x16x32_bf16 v[232:235], v[72:75], a[108:111], v[232:235]
  v_mfma_f32_16x16x32_bf16 v[236:239], v[76:79], a[108:111], v[236:239]
  ds_read_b128 v[64:67], v8 offset:36864
  ds_read_b128 v[68:71], v8 offset:37888
  ds_read_b128 v[72:75], v8 offset:38912
  ds_read_b128 v[76:79], v8 offset:39936
  s_waitcnt lgkmcnt(4)
  v_mfma_f32_16x16x32_bf16 v[184:187], v[48:51], a[16:19], v[184:187]
  buffer_store_dwordx4 v[200:203], v13, s[40:43], 0 offen offset:0 sc0 sc1
  v_mfma_f32_16x16x32_bf16 v[188:191], v[52:55], a[16:19], v[188:191]
  v_cvt_pk_bf16_f32 v224, v224, v225
  v_mfma_f32_16x16x32_bf16 v[208:211], v[48:51], a[64:67], v[208:211]
  v_cvt_pk_bf16_f32 v225, v226, v227
  v_mfma_f32_16x16x32_bf16 v[212:215], v[52:55], a[64:67], v[212:215]
  v_cvt_pk_bf16_f32 v226, v228, v229
  v_mfma_f32_16x16x32_bf16 v[232:235], v[48:51], a[112:115], v[232:235]
  v_cvt_pk_bf16_f32 v227, v230, v231
  v_mfma_f32_16x16x32_bf16 v[236:239], v[52:55], a[112:115], v[236:239]
  buffer_store_dwordx4 v[224:227], v14, s[40:43], 0 offen offset:0 sc0 sc1
  v_mfma_f32_16x16x32_bf16 v[184:187], v[56:59], a[20:23], v[184:187]
  v_mfma_f32_16x16x32_bf16 v[188:191], v[60:63], a[20:23], v[188:191]
  v_mfma_f32_16x16x32_bf16 v[208:211], v[56:59], a[68:71], v[208:211]
  v_mfma_f32_16x16x32_bf16 v[212:215], v[60:63], a[68:71], v[212:215]
  v_mfma_f32_16x16x32_bf16 v[232:235], v[56:59], a[116:119], v[232:235]
  v_mfma_f32_16x16x32_bf16 v[236:239], v[60:63], a[116:119], v[236:239]
  ds_read_b128 v[48:51], v8 offset:40960
  ds_read_b128 v[52:55], v8 offset:41984
  ds_read_b128 v[56:59], v8 offset:43008
  ds_read_b128 v[60:63], v8 offset:44032
  s_waitcnt lgkmcnt(4)
  v_mfma_f32_16x16x32_bf16 v[184:187], v[64:67], a[24:27], v[184:187]
  v_mfma_f32_16x16x32_bf16 v[188:191], v[68:71], a[24:27], v[188:191]
  v_mfma_f32_16x16x32_bf16 v[208:211], v[64:67], a[72:75], v[208:211]
  v_mfma_f32_16x16x32_bf16 v[212:215], v[68:71], a[72:75], v[212:215]
  v_mfma_f32_16x16x32_bf16 v[232:235], v[64:67], a[120:123], v[232:235]
  v_mfma_f32_16x16x32_bf16 v[236:239], v[68:71], a[120:123], v[236:239]
  v_mfma_f32_16x16x32_bf16 v[184:187], v[72:75], a[28:31], v[184:187]
  v_mfma_f32_16x16x32_bf16 v[188:191], v[76:79], a[28:31], v[188:191]
  v_mfma_f32_16x16x32_bf16 v[208:211], v[72:75], a[76:79], v[208:211]
  v_mfma_f32_16x16x32_bf16 v[212:215], v[76:79], a[76:79], v[212:215]
  v_mfma_f32_16x16x32_bf16 v[232:235], v[72:75], a[124:127], v[232:235]
  v_mfma_f32_16x16x32_bf16 v[236:239], v[76:79], a[124:127], v[236:239]
  ds_read_b128 v[64:67], v8 offset:45056
  ds_read_b128 v[68:71], v8 offset:46080
  ds_read_b128 v[72:75], v8 offset:47104
  ds_read_b128 v[76:79], v8 offset:48128
  s_waitcnt lgkmcnt(4)
  v_mfma_f32_16x16x32_bf16 v[184:187], v[48:51], a[32:35], v[184:187]
  v_mfma_f32_16x16x32_bf16 v[188:191], v[52:55], a[32:35], v[188:191]
  v_mfma_f32_16x16x32_bf16 v[208:211], v[48:51], a[80:83], v[208:211]
  v_mfma_f32_16x16x32_bf16 v[212:215], v[52:55], a[80:83], v[212:215]
  v_mfma_f32_16x16x32_bf16 v[232:235], v[48:51], a[128:131], v[232:235]
  v_mfma_f32_16x16x32_bf16 v[236:239], v[52:55], a[128:131], v[236:239]
  v_mfma_f32_16x16x32_bf16 v[184:187], v[56:59], a[36:39], v[184:187]
  v_mfma_f32_16x16x32_bf16 v[188:191], v[60:63], a[36:39], v[188:191]
  v_mfma_f32_16x16x32_bf16 v[208:211], v[56:59], a[84:87], v[208:211]
  v_mfma_f32_16x16x32_bf16 v[212:215], v[60:63], a[84:87], v[212:215]
  v_mfma_f32_16x16x32_bf16 v[232:235], v[56:59], a[132:135], v[232:235]
  v_mfma_f32_16x16x32_bf16 v[236:239], v[60:63], a[132:135], v[236:239]
  ds_read_b128 v[80:83], v6 offset:0
  ds_read_b128 v[84:87], v6 offset:1024
  ds_read_b128 v[88:91], v2 offset:0
  ds_read_b128 v[92:95], v2 offset:1024
  ds_read_b128 v[96:99], v6 offset:2048
  ds_read_b128 v[100:103], v6 offset:3072
  ds_read_b128 v[104:107], v2 offset:2048
  ds_read_b128 v[108:111], v2 offset:3072
  s_waitcnt lgkmcnt(8)
  v_mfma_f32_16x16x32_bf16 v[184:187], v[64:67], a[40:43], v[184:187]
  v_mfma_f32_16x16x32_bf16 v[188:191], v[68:71], a[40:43], v[188:191]
  v_mfma_f32_16x16x32_bf16 v[208:211], v[64:67], a[88:91], v[208:211]
  v_mfma_f32_16x16x32_bf16 v[212:215], v[68:71], a[88:91], v[212:215]
  v_mfma_f32_16x16x32_bf16 v[232:235], v[64:67], a[136:139], v[232:235]
  v_mfma_f32_16x16x32_bf16 v[236:239], v[68:71], a[136:139], v[236:239]
  v_mfma_f32_16x16x32_bf16 v[184:187], v[72:75], a[44:47], v[184:187]
  v_mfma_f32_16x16x32_bf16 v[188:191], v[76:79], a[44:47], v[188:191]
  v_mfma_f32_16x16x32_bf16 v[208:211], v[72:75], a[92:95], v[208:211]
  v_mfma_f32_16x16x32_bf16 v[212:215], v[76:79], a[92:95], v[212:215]
  v_mfma_f32_16x16x32_bf16 v[232:235], v[72:75], a[140:143], v[232:235]
  v_mfma_f32_16x16x32_bf16 v[236:239], v[76:79], a[140:143], v[236:239]
  ds_read_b128 v[112:115], v6 offset:4096
  ds_read_b128 v[116:119], v6 offset:5120
  ds_read_b128 v[120:123], v2 offset:4096
  ds_read_b128 v[124:127], v2 offset:5120
  s_waitcnt lgkmcnt(8)
  v_mfma_f32_16x16x32_bf16 v[192:195], v[80:83], a[0:3], v[192:195]
  v_mfma_f32_16x16x32_bf16 v[196:199], v[84:87], a[0:3], v[196:199]
  v_mfma_f32_16x16x32_bf16 v[248:251], v[88:91], a[144:147], v[248:251]
  v_mfma_f32_16x16x32_bf16 v[216:219], v[80:83], a[48:51], v[216:219]
  v_mfma_f32_16x16x32_bf16 v[220:223], v[84:87], a[48:51], v[220:223]
  v_mfma_f32_16x16x32_bf16 v[252:255], v[92:95], a[144:147], v[252:255]
  v_mfma_f32_16x16x32_bf16 v[240:243], v[80:83], a[96:99], v[240:243]
  v_mfma_f32_16x16x32_bf16 v[244:247], v[84:87], a[96:99], v[244:247]
  ds_read_b128 v[128:131], v6 offset:6144
  ds_read_b128 v[132:135], v6 offset:7168
  ds_read_b128 v[136:139], v2 offset:6144
  ds_read_b128 v[140:143], v2 offset:7168
  s_waitcnt lgkmcnt(8)
  v_mfma_f32_16x16x32_bf16 v[192:195], v[96:99], a[4:7], v[192:195]
  v_cvt_pk_bf16_f32 v184, v184, v185
  v_mfma_f32_16x16x32_bf16 v[196:199], v[100:103], a[4:7], v[196:199]
  v_cvt_pk_bf16_f32 v185, v186, v187
  v_mfma_f32_16x16x32_bf16 v[248:251], v[104:107], a[148:151], v[248:251]
  v_cvt_pk_bf16_f32 v186, v188, v189
  v_mfma_f32_16x16x32_bf16 v[216:219], v[96:99], a[52:55], v[216:219]
  v_cvt_pk_bf16_f32 v187, v190, v191
  v_mfma_f32_16x16x32_bf16 v[220:223], v[100:103], a[52:55], v[220:223]
  buffer_store_dwordx4 v[184:187], v12, s[40:43], 0 offen offset:64 sc0 sc1
  v_mfma_f32_16x16x32_bf16 v[252:255], v[108:111], a[148:151], v[252:255]
  v_cvt_pk_bf16_f32 v208, v208, v209
  v_mfma_f32_16x16x32_bf16 v[240:243], v[96:99], a[100:103], v[240:243]
  v_mfma_f32_16x16x32_bf16 v[244:247], v[100:103], a[100:103], v[244:247]
  ds_read_b128 v[80:83], v6 offset:8192
  ds_read_b128 v[84:87], v6 offset:9216
  ds_read_b128 v[88:91], v2 offset:8192
  ds_read_b128 v[92:95], v2 offset:9216
  s_waitcnt lgkmcnt(8)
  v_mfma_f32_16x16x32_bf16 v[192:195], v[112:115], a[8:11], v[192:195]
  v_cvt_pk_bf16_f32 v209, v210, v211
  v_mfma_f32_16x16x32_bf16 v[196:199], v[116:119], a[8:11], v[196:199]
  v_cvt_pk_bf16_f32 v210, v212, v213
  v_mfma_f32_16x16x32_bf16 v[248:251], v[120:123], a[152:155], v[248:251]
  v_cvt_pk_bf16_f32 v211, v214, v215
  v_mfma_f32_16x16x32_bf16 v[216:219], v[112:115], a[56:59], v[216:219]
  buffer_store_dwordx4 v[208:211], v13, s[40:43], 0 offen offset:64 sc0 sc1
  v_mfma_f32_16x16x32_bf16 v[220:223], v[116:119], a[56:59], v[220:223]
  v_cvt_pk_bf16_f32 v232, v232, v233
  v_mfma_f32_16x16x32_bf16 v[252:255], v[124:127], a[152:155], v[252:255]
  v_cvt_pk_bf16_f32 v233, v234, v235
  v_mfma_f32_16x16x32_bf16 v[240:243], v[112:115], a[104:107], v[240:243]
  v_mfma_f32_16x16x32_bf16 v[244:247], v[116:119], a[104:107], v[244:247]
  ds_read_b128 v[96:99], v6 offset:10240
  ds_read_b128 v[100:103], v6 offset:11264
  ds_read_b128 v[104:107], v2 offset:10240
  ds_read_b128 v[108:111], v2 offset:11264
  s_waitcnt lgkmcnt(8)
  v_mfma_f32_16x16x32_bf16 v[192:195], v[128:131], a[12:15], v[192:195]
  v_cvt_pk_bf16_f32 v234, v236, v237
  v_mfma_f32_16x16x32_bf16 v[196:199], v[132:135], a[12:15], v[196:199]
  v_cvt_pk_bf16_f32 v235, v238, v239
  v_mfma_f32_16x16x32_bf16 v[248:251], v[136:139], a[156:159], v[248:251]
  buffer_store_dwordx4 v[232:235], v14, s[40:43], 0 offen offset:64 sc0 sc1
  v_mfma_f32_16x16x32_bf16 v[216:219], v[128:131], a[60:63], v[216:219]
  v_mfma_f32_16x16x32_bf16 v[220:223], v[132:135], a[60:63], v[220:223]
  v_mfma_f32_16x16x32_bf16 v[252:255], v[140:143], a[156:159], v[252:255]
  v_mfma_f32_16x16x32_bf16 v[240:243], v[128:131], a[108:111], v[240:243]
  v_mfma_f32_16x16x32_bf16 v[244:247], v[132:135], a[108:111], v[244:247]
  ds_read_b128 v[112:115], v6 offset:12288
  ds_read_b128 v[116:119], v6 offset:13312
  ds_read_b128 v[120:123], v2 offset:12288
  ds_read_b128 v[124:127], v2 offset:13312
  s_waitcnt lgkmcnt(8)
  v_mfma_f32_16x16x32_bf16 v[192:195], v[80:83], a[16:19], v[192:195]
  v_mfma_f32_16x16x32_bf16 v[196:199], v[84:87], a[16:19], v[196:199]
  v_mfma_f32_16x16x32_bf16 v[248:251], v[88:91], a[160:163], v[248:251]
  v_mfma_f32_16x16x32_bf16 v[216:219], v[80:83], a[64:67], v[216:219]
  v_mfma_f32_16x16x32_bf16 v[220:223], v[84:87], a[64:67], v[220:223]
  v_mfma_f32_16x16x32_bf16 v[252:255], v[92:95], a[160:163], v[252:255]
  v_mfma_f32_16x16x32_bf16 v[240:243], v[80:83], a[112:115], v[240:243]
  v_mfma_f32_16x16x32_bf16 v[244:247], v[84:87], a[112:115], v[244:247]
  ds_read_b128 v[128:131], v6 offset:14336
  ds_read_b128 v[132:135], v6 offset:15360
  ds_read_b128 v[136:139], v2 offset:14336
  ds_read_b128 v[140:143], v2 offset:15360
  s_waitcnt lgkmcnt(8)
  v_mfma_f32_16x16x32_bf16 v[192:195], v[96:99], a[20:23], v[192:195]
  v_mfma_f32_16x16x32_bf16 v[196:199], v[100:103], a[20:23], v[196:199]
  v_mfma_f32_16x16x32_bf16 v[248:251], v[104:107], a[164:167], v[248:251]
  v_mfma_f32_16x16x32_bf16 v[216:219], v[96:99], a[68:71], v[216:219]
  v_mfma_f32_16x16x32_bf16 v[220:223], v[100:103], a[68:71], v[220:223]
  v_mfma_f32_16x16x32_bf16 v[252:255], v[108:111], a[164:167], v[252:255]
  v_mfma_f32_16x16x32_bf16 v[240:243], v[96:99], a[116:119], v[240:243]
  v_mfma_f32_16x16x32_bf16 v[244:247], v[100:103], a[116:119], v[244:247]
  ds_read_b128 v[80:83], v6 offset:16384
  ds_read_b128 v[84:87], v6 offset:17408
  ds_read_b128 v[88:91], v2 offset:16384
  ds_read_b128 v[92:95], v2 offset:17408
  s_waitcnt lgkmcnt(8)
  v_mfma_f32_16x16x32_bf16 v[192:195], v[112:115], a[24:27], v[192:195]
  v_mfma_f32_16x16x32_bf16 v[196:199], v[116:119], a[24:27], v[196:199]
  v_mfma_f32_16x16x32_bf16 v[248:251], v[120:123], a[168:171], v[248:251]
  v_mfma_f32_16x16x32_bf16 v[216:219], v[112:115], a[72:75], v[216:219]
  v_mfma_f32_16x16x32_bf16 v[220:223], v[116:119], a[72:75], v[220:223]
  v_mfma_f32_16x16x32_bf16 v[252:255], v[124:127], a[168:171], v[252:255]
  v_mfma_f32_16x16x32_bf16 v[240:243], v[112:115], a[120:123], v[240:243]
  v_mfma_f32_16x16x32_bf16 v[244:247], v[116:119], a[120:123], v[244:247]
  ds_read_b128 v[96:99], v6 offset:18432
  ds_read_b128 v[100:103], v6 offset:19456
  ds_read_b128 v[104:107], v2 offset:18432
  ds_read_b128 v[108:111], v2 offset:19456
  s_waitcnt lgkmcnt(8)
  v_mfma_f32_16x16x32_bf16 v[192:195], v[128:131], a[28:31], v[192:195]
  v_mfma_f32_16x16x32_bf16 v[196:199], v[132:135], a[28:31], v[196:199]
  v_mfma_f32_16x16x32_bf16 v[248:251], v[136:139], a[172:175], v[248:251]
  v_mfma_f32_16x16x32_bf16 v[216:219], v[128:131], a[76:79], v[216:219]
  v_mfma_f32_16x16x32_bf16 v[220:223], v[132:135], a[76:79], v[220:223]
  v_mfma_f32_16x16x32_bf16 v[252:255], v[140:143], a[172:175], v[252:255]
  v_mfma_f32_16x16x32_bf16 v[240:243], v[128:131], a[124:127], v[240:243]
  v_mfma_f32_16x16x32_bf16 v[244:247], v[132:135], a[124:127], v[244:247]
  ds_read_b128 v[112:115], v6 offset:20480
  ds_read_b128 v[116:119], v6 offset:21504
  ds_read_b128 v[120:123], v2 offset:20480
  ds_read_b128 v[124:127], v2 offset:21504
  s_waitcnt lgkmcnt(8)
  v_mfma_f32_16x16x32_bf16 v[192:195], v[80:83], a[32:35], v[192:195]
  v_mfma_f32_16x16x32_bf16 v[196:199], v[84:87], a[32:35], v[196:199]
  v_mfma_f32_16x16x32_bf16 v[248:251], v[88:91], a[176:179], v[248:251]
  v_mfma_f32_16x16x32_bf16 v[216:219], v[80:83], a[80:83], v[216:219]
  v_mfma_f32_16x16x32_bf16 v[220:223], v[84:87], a[80:83], v[220:223]
  v_mfma_f32_16x16x32_bf16 v[252:255], v[92:95], a[176:179], v[252:255]
  v_mfma_f32_16x16x32_bf16 v[240:243], v[80:83], a[128:131], v[240:243]
  v_mfma_f32_16x16x32_bf16 v[244:247], v[84:87], a[128:131], v[244:247]
  ds_read_b128 v[128:131], v6 offset:22528
  ds_read_b128 v[132:135], v6 offset:23552
  ds_read_b128 v[136:139], v2 offset:22528
  ds_read_b128 v[140:143], v2 offset:23552
  s_waitcnt lgkmcnt(8)
  v_mfma_f32_16x16x32_bf16 v[192:195], v[96:99], a[36:39], v[192:195]
  v_mfma_f32_16x16x32_bf16 v[196:199], v[100:103], a[36:39], v[196:199]
  v_mfma_f32_16x16x32_bf16 v[248:251], v[104:107], a[180:183], v[248:251]
  v_mfma_f32_16x16x32_bf16 v[216:219], v[96:99], a[84:87], v[216:219]
  v_mfma_f32_16x16x32_bf16 v[220:223], v[100:103], a[84:87], v[220:223]
  v_mfma_f32_16x16x32_bf16 v[252:255], v[108:111], a[180:183], v[252:255]
  v_mfma_f32_16x16x32_bf16 v[240:243], v[96:99], a[132:135], v[240:243]
  v_mfma_f32_16x16x32_bf16 v[244:247], v[100:103], a[132:135], v[244:247]
  s_waitcnt lgkmcnt(4)
  v_mfma_f32_16x16x32_bf16 v[192:195], v[112:115], a[40:43], v[192:195]
  v_mfma_f32_16x16x32_bf16 v[196:199], v[116:119], a[40:43], v[196:199]
  v_mfma_f32_16x16x32_bf16 v[248:251], v[120:123], a[184:187], v[248:251]
  v_mfma_f32_16x16x32_bf16 v[216:219], v[112:115], a[88:91], v[216:219]
  v_mfma_f32_16x16x32_bf16 v[220:223], v[116:119], a[88:91], v[220:223]
  v_mfma_f32_16x16x32_bf16 v[252:255], v[124:127], a[184:187], v[252:255]
  v_mfma_f32_16x16x32_bf16 v[240:243], v[112:115], a[136:139], v[240:243]
  v_mfma_f32_16x16x32_bf16 v[244:247], v[116:119], a[136:139], v[244:247]
  s_waitcnt lgkmcnt(0)
  v_mfma_f32_16x16x32_bf16 v[192:195], v[128:131], a[44:47], v[192:195]
  v_mfma_f32_16x16x32_bf16 v[196:199], v[132:135], a[44:47], v[196:199]
  v_mfma_f32_16x16x32_bf16 v[248:251], v[136:139], a[188:191], v[248:251]
  v_mfma_f32_16x16x32_bf16 v[216:219], v[128:131], a[92:95], v[216:219]
  v_mfma_f32_16x16x32_bf16 v[220:223], v[132:135], a[92:95], v[220:223]
  v_mfma_f32_16x16x32_bf16 v[252:255], v[140:143], a[188:191], v[252:255]
  v_mfma_f32_16x16x32_bf16 v[240:243], v[128:131], a[140:143], v[240:243]
  v_mfma_f32_16x16x32_bf16 v[244:247], v[132:135], a[140:143], v[244:247]
  s_nop 0
  v_cvt_pk_bf16_f32 v192, v192, v193
  v_cvt_pk_bf16_f32 v193, v194, v195
  v_cvt_pk_bf16_f32 v194, v196, v197
  v_cvt_pk_bf16_f32 v195, v198, v199
  buffer_store_dwordx4 v[192:195], v12, s[40:43], 0 offen offset:128 sc0 sc1
  v_cvt_pk_bf16_f32 v216, v216, v217
  v_cvt_pk_bf16_f32 v217, v218, v219
  v_cvt_pk_bf16_f32 v218, v220, v221
  v_cvt_pk_bf16_f32 v219, v222, v223
  buffer_store_dwordx4 v[216:219], v13, s[40:43], 0 offen offset:128 sc0 sc1
  v_cvt_pk_bf16_f32 v240, v240, v241
  v_cvt_pk_bf16_f32 v241, v242, v243
  v_cvt_pk_bf16_f32 v242, v244, v245
  v_cvt_pk_bf16_f32 v243, v246, v247
  buffer_store_dwordx4 v[240:243], v14, s[40:43], 0 offen offset:128 sc0 sc1
  s_cmp_eq_u32 s22, 3
  s_cbranch_scc1 L_norem
  v_cvt_pk_bf16_f32 v248, v248, v249
  v_cvt_pk_bf16_f32 v249, v250, v251
  v_cvt_pk_bf16_f32 v250, v252, v253
  v_cvt_pk_bf16_f32 v251, v254, v255
  s_mov_b32 exec_lo, 0x000f000f
  s_mov_b32 exec_hi, 0x000f000f
  buffer_store_dwordx4 v[248:251], v15, s[40:43], 0 offen sc0 sc1
  s_mov_b64 exec, -1
L_norem:
L_end:
  s_endpgm
L_code_end:
.section .rodata,"a"
.p2align 6
.amdhsa_kernel standalone__modern_conv_block_slak__vision_kernel
  .amdhsa_next_free_vgpr 512
  .amdhsa_next_free_sgpr 102
  .amdhsa_accum_offset 256
  .amdhsa_group_segment_fixed_size 0
  .amdhsa_kernarg_size 72
  .amdhsa_user_sgpr_count 2
  .amdhsa_user_sgpr_kernarg_segment_ptr 1
  .amdhsa_system_sgpr_workgroup_id_x 1
  .amdhsa_float_denorm_mode_32 3
.end_amdhsa_kernel
```
